```python
import torch

def _softmax(x, axis=-1):
    return torch.softmax(x, dim=axis)
def _gelu(x):
    return torch.nn.functional.gelu(x, approximate="tanh")
def _silu(x):
    return torch.nn.functional.silu(x)
def _sigmoid(x):
    return torch.sigmoid(x)
def _layernorm(x, axis=-1, eps=1e-5):
    m = x.mean(dim=axis, keepdim=True)
    v = x.var(dim=axis, keepdim=True, unbiased=False)
    return (x - m) / torch.sqrt(v + eps)
def _scatter_add(tgt, idx, src, axis=0):
    return tgt.clone().index_add_(axis, idx, src)
def _segment_sum(src, seg, n):
    out = torch.zeros((n,) + src.shape[1:], dtype=src.dtype)
    return out.index_add_(0, seg, src)
def _pad(x, pw):
    flat = tuple(v for pair in reversed(pw) for v in pair)
    return torch.nn.functional.pad(x, flat)

kernel_name = 'concat_heads__ssm_conv_h3__ssm_conv_h3__prompt'

def setup_inputs():

    _w = (lambda a: (lambda t: t.to(torch.bfloat16) if t.is_floating_point() else t)(torch.as_tensor(a)))
    def _A_setup():
        B, S, D = 1, 2048, 576
        ks = 4
        return {
            "q": _w((lambda *s: torch.randn(*s, dtype=torch.bfloat16) * 0.05)(B, S, D)),
            "k": _w((lambda *s: torch.randn(*s, dtype=torch.bfloat16) * 0.05)(B, S, D)),
            "v": _w((lambda *s: torch.randn(*s, dtype=torch.bfloat16) * 0.05)(B, S, D)),
            "shift_k": _w((lambda *s: torch.randn(*s, dtype=torch.bfloat16) * 0.05)(D, ks) * 0.5),
            "ssm_k": _w((lambda *s: torch.randn(*s, dtype=torch.bfloat16) * 0.05)(D, S) * (1.0 / S ** 0.5)),
            "ssm_D": _w((lambda *s: torch.randn(*s, dtype=torch.bfloat16) * 0.05)(D)),
        }
    _A_in = _A_setup()

    def _B_setup():
        B, S, D = 1, 2048, 576
        ks = 4
        return {
            "q": _w((lambda *s: torch.randn(*s, dtype=torch.bfloat16) * 0.05)(B, S, D)),
            "k": _w((lambda *s: torch.randn(*s, dtype=torch.bfloat16) * 0.05)(B, S, D)),
            "v": _w((lambda *s: torch.randn(*s, dtype=torch.bfloat16) * 0.05)(B, S, D)),
            "shift_k": _w((lambda *s: torch.randn(*s, dtype=torch.bfloat16) * 0.05)(D, ks) * 0.5),
            "ssm_k": _w((lambda *s: torch.randn(*s, dtype=torch.bfloat16) * 0.05)(D, S) * (1.0 / S ** 0.5)),
            "ssm_D": _w((lambda *s: torch.randn(*s, dtype=torch.bfloat16) * 0.05)(D)),
        }
    _B_in = _B_setup()

    return {
        "A_q": _A_in["q"],
        "A_k": _A_in["k"],
        "A_v": _A_in["v"],
        "A_shift_k": _A_in["shift_k"],
        "A_ssm_k": _A_in["ssm_k"],
        "A_ssm_D": _A_in["ssm_D"],
        "B_q": _B_in["q"],
        "B_k": _B_in["k"],
        "B_v": _B_in["v"],
        "B_shift_k": _B_in["shift_k"],
        "B_ssm_k": _B_in["ssm_k"],
        "B_ssm_D": _B_in["ssm_D"],
    }

def reference(A_q, A_k, A_v, A_shift_k, A_ssm_k, A_ssm_D, B_q, B_k, B_v, B_shift_k, B_ssm_k, B_ssm_D):
    def _A_ref(q, k, v, shift_k, ssm_k, ssm_D):
        B, S, D = q.shape
        ks = shift_k.shape[-1]
        k_pad = _pad(k, ((0, 0), (ks - 1, 0), (0, 0)))
        k_shift = torch.zeros_like(k)
        for t in range(ks):
            k_shift = k_shift + k_pad[:, t:t + S, :] * shift_k[:, ks - 1 - t][None, None, :]
        kv = k_shift * v
        L = 2 * S
        kv_pad = _pad(kv, ((0, 0), (0, S), (0, 0)))
        kf_pad = _pad(ssm_k, ((0, 0), (0, S)))
        kv_f = (lambda x, axes=(-2,-1): torch.fft.rfft2(x.float(), dim=axes))(kv_pad[:, None, :, :], axes=(1, 2))
        kf_f = (lambda x, axes=(-2,-1): torch.fft.rfft2(x.float(), dim=axes))(kf_pad[:, None, :], axes=(1, 2))
        kf_f = (lambda x, *d: x.permute(*d))(kf_f, 1, 2, 0)
        y_f = kv_f * kf_f[None, :, :, :]
        y = (lambda x, s, axes=(-2,-1): torch.fft.irfft2(x, s=s, dim=axes).to(torch.bfloat16))(y_f, (1, L), axes=(1, 2))[:, 0, :S, :]
        y = y + kv * ssm_D[None, None, :]
        return q * y

    def _B_ref(q, k, v, shift_k, ssm_k, ssm_D):
        B, S, D = q.shape
        ks = shift_k.shape[-1]
        k_pad = _pad(k, ((0, 0), (ks - 1, 0), (0, 0)))
        k_shift = torch.zeros_like(k)
        for t in range(ks):
            k_shift = k_shift + k_pad[:, t:t + S, :] * shift_k[:, ks - 1 - t][None, None, :]
        kv = k_shift * v
        L = 2 * S
        kv_pad = _pad(kv, ((0, 0), (0, S), (0, 0)))
        kf_pad = _pad(ssm_k, ((0, 0), (0, S)))
        kv_f = (lambda x, axes=(-2,-1): torch.fft.rfft2(x.float(), dim=axes))(kv_pad[:, None, :, :], axes=(1, 2))
        kf_f = (lambda x, axes=(-2,-1): torch.fft.rfft2(x.float(), dim=axes))(kf_pad[:, None, :], axes=(1, 2))
        kf_f = (lambda x, *d: x.permute(*d))(kf_f, 1, 2, 0)
        y_f = kv_f * kf_f[None, :, :, :]
        y = (lambda x, s, axes=(-2,-1): torch.fft.irfft2(x, s=s, dim=axes).to(torch.bfloat16))(y_f, (1, L), axes=(1, 2))[:, 0, :S, :]
        y = y + kv * ssm_D[None, None, :]
        return q * y

    a = _A_ref(A_q, A_k, A_v, A_shift_k, A_ssm_k, A_ssm_D)
    b = _B_ref(B_q, B_k, B_v, B_shift_k, B_ssm_k, B_ssm_D)
    return torch.concatenate([a, b], axis=-1)
```

```asm
; @launch grid=(256,1,1) block=(896,1,1) lds=163424
.amdgcn_target "amdgcn-amd-amdhsa--gfx950"
.text
.globl concat_heads__ssm_conv_h3__ssm_conv_h3__prompt_kernel
.p2align 8
.type concat_heads__ssm_conv_h3__ssm_conv_h3__prompt_kernel,@function
concat_heads__ssm_conv_h3__ssm_conv_h3__prompt_kernel:
    s_cmp_ge_u32 s2, 256
    s_cbranch_scc1 L_exit
    s_load_dwordx16 s[16:31], s[0:1], 0
    s_load_dwordx8 s[32:39], s[0:1], 64
    s_load_dwordx4 s[40:43], s[0:1], 96
    s_load_dwordx2 s[44:45], s[0:1], 112
    s_getpc_b64 s[8:9]
L_pc:
    s_bfe_u32 s10, s2, 196611
    s_mul_i32 s10, s10, 24
    v_cmp_gt_u32 vcc, 16, v0
    v_add_u32 v2, s10, v0
    s_nop 0
    v_cndmask_b32 v2, v2, v0, vcc
    v_lshlrev_b32 v2, 7, v2
    v_min_u32 v2, L_exit-L_pc, v2
    v_cmp_gt_u32 vcc, 40, v0
    s_and_saveexec_b64 s[10:11], vcc
    s_cbranch_execz L_pd
    global_load_dword v17, v2, s[8:9]
L_pd:
    s_mov_b64 exec, s[10:11]
    v_lshrrev_b32 v1, 6, v0
    s_and_b32 s4, s2, 7
    v_readfirstlane_b32 s3, v1
    v_and_b32 v0, 63, v0
    s_lshr_b32 s5, s2, 3
    s_lshr_b32 s6, s4, 2
    s_and_b32 s7, s4, 3
    s_cmp_eq_u32 s3, 0
    s_cbranch_scc1 L_Si
    s_sub_u32 s46, s3, 6
    s_cmp_lt_u32 s46, 4
    s_cbranch_scc1 L_Ci
    s_cmp_gt_u32 s3, 9
    s_cselect_b32 s8, 4, 0
    s_sub_u32 s100, s3, s8
    s_sub_u32 s100, s100, 2
    s_cselect_b32 s100, 8, s100
    s_and_b32 s8, s100, 4
    s_cselect_b64 vcc, -1, 0
    s_lshl_b32 s9, s5, 1
    s_and_b32 s10, s100, 4
    s_lshl_b32 s10, s10, 4
    s_add_u32 s9, s9, s10
    s_bfe_u32 s10, s100, 65537
    s_add_u32 s9, s9, s10
    s_lshl_b32 s8, s7, 1
    s_and_b32 s11, s100, 1
    s_add_u32 s8, s8, s11
    s_lshl_b32 s10, s7, 5
    s_add_u32 s10, s10, s5
    v_lshrrev_b32 v2, 3, v0
    v_mul_u32_u24 v2, 1152, v2
    v_and_b32 v3, 7, v0
    v_lshl_add_u32 v2, v3, 4, v2
    s_cmp_eq_u32 s100, 8
    s_cselect_b32 s46, 8, s8
    s_cselect_b32 s47, s10, s9
    s_mul_i32 s8, s47, 18432
    s_lshl_b32 s9, s46, 7
    s_add_u32 s15, s8, s9
    v_add_u32 v1, s15, v2
    s_lshl_b32 s10, s46, 9
    v_lshl_add_u32 v3, v0, 4, s10
    v_lshl_add_u32 v4, v0, 4, s9
    v_add_u32 v2, 4294963840, v1
    s_mov_b32 s50, 2359296
    s_mov_b32 s51, 0x00020000
    s_mov_b32 s54, 2359296
    s_mov_b32 s55, 0x00020000
    s_mov_b32 s62, 4608
    s_mov_b32 s63, 0x00020000
    s_mul_i32 s101, s100, 5120
    s_add_u32 s101, s101, 92800
    s_cmp_eq_u32 s100, 8
    s_cselect_b32 s101, 135200, s101
    s_add_u32 s8, s101, 1024
    s_cmp_eq_u32 s6, 0
    s_waitcnt lgkmcnt(0)
    s_cselect_b64 s[48:49], s[18:19], s[30:31]
    s_cbranch_vccnz L_E2i
    s_mov_b32 m0, s101
    s_mov_b32 s9, 5760
    buffer_load_dwordx4 v2, s[48:51], 0 offen nt lds
    s_mov_b32 m0, s8
    s_cselect_b64 s[52:53], s[20:21], s[32:33]
    buffer_load_dwordx4 v1, s[48:51], s9 offen nt lds
    s_cselect_b64 s[60:61], s[22:23], s[34:35]
    s_cselect_b64 s[64:65], s[26:27], s[38:39]
    s_cselect_b64 s[56:57], s[16:17], s[28:29]
    s_cselect_b64 s[84:85], s[24:25], s[36:37]
    s_add_u32 s8, s101, 2048
    s_mov_b32 m0, s8
    s_mov_b32 s9, 14976
    s_mov_b64 exec, 0xffffff
    s_add_u32 s8, s101, 4480
    buffer_load_dwordx4 v1, s[48:51], s9 offen nt lds
    s_mov_b32 m0, s8
    s_mov_b32 exec_lo, -1
    s_add_u32 s8, s101, 4992
    buffer_load_dwordx4 v3, s[60:63], 0 offen lds
    s_mov_b32 s66, 1152
    s_mov_b32 s67, 0x00020000
    s_mov_b32 m0, s8
    s_mov_b32 exec_lo, 0xff
    s_add_u32 s8, s101, 2432
    buffer_load_dwordx4 v4, s[64:67], 0 offen lds
    s_mov_b32 m0, s8
    s_mov_b64 exec, -1
    s_add_u32 s8, s101, 3456
    buffer_load_dwordx4 v1, s[52:55], 0 offen nt lds
    s_mov_b32 m0, s8
    s_mov_b32 s9, 9216
    buffer_load_dwordx4 v1, s[52:55], s9 offen nt lds
    s_barrier
    s_branch L_Em
L_E2i:
    s_cselect_b64 s[52:53], s[20:21], s[32:33]
    s_cselect_b64 s[60:61], s[22:23], s[34:35]
    s_cselect_b64 s[64:65], s[26:27], s[38:39]
    s_cselect_b64 s[56:57], s[16:17], s[28:29]
    s_cselect_b64 s[84:85], s[24:25], s[36:37]
    s_barrier
    s_branch L_Em
L_Ci:
    s_barrier
    s_and_b32 s9, s5, 12
    s_add_u32 s9, s9, s46
    s_lshl_b32 s9, s9, 2
    s_and_b32 s10, s5, 3
    s_add_u32 s9, s9, s10
    s_lshr_b32 s10, s5, 4
    s_lshl_b32 s11, s7, 1
    s_add_u32 s10, s10, s11
    s_lshl_b32 s10, s10, 6
    s_add_u32 s8, s9, s10
    s_lshl_b32 s8, s8, 12
    v_lshl_add_u32 v48, v0, 4, s8
    s_lshr_b32 s10, s5, 4
    s_lshl_b32 s11, s7, 1
    s_add_u32 s10, s10, s11
    s_lshl_b32 s10, s10, 7
    s_mul_i32 s47, s6, 1152
    s_add_u32 s47, s47, s10
    s_and_b32 s15, s5, 15
    s_mov_b32 s86, 2359296
    s_mov_b32 s87, 0x00020000
    s_mov_b32 s78, 4718592
    s_mov_b32 s79, 0x00020000
    s_lshl_b32 s8, s46, 4
    v_lshrrev_b32 v51, 2, v0
    v_add_u32 v51, s8, v51
    v_add_u32 v49, s15, v51
    v_and_b32 v49, 15, v49
    v_lshl_add_u32 v51, v51, 4, v49
    v_mul_u32_u24 v51, 2304, v51
    v_add_u32 v51, s47, v51
    s_cmp_eq_u32 s6, 0
    s_waitcnt lgkmcnt(0)
    s_cselect_b64 s[84:85], s[24:25], s[36:37]
    buffer_load_dwordx4 v[66:69], v48, s[84:87], 0 offen offset:0 nt
    buffer_load_dwordx4 v[74:77], v48, s[84:87], 0 offen offset:1024 nt
    s_mov_b64 exec, 1
    buffer_load_dwordx2 v[72:73], v48, s[84:87], 0 offen offset:1016 nt
    s_mov_b64 exec, -1
    buffer_load_dwordx4 v[114:117], v48, s[84:87], 0 offen offset:2048 nt
    s_mov_b64 exec, 1
    buffer_load_dwordx2 v[112:113], v48, s[84:87], 0 offen offset:2040 nt
    s_mov_b64 exec, -1
    buffer_load_dwordx4 v[122:125], v48, s[84:87], 0 offen offset:3072 nt
    s_mov_b64 exec, 1
    buffer_load_dwordx2 v[120:121], v48, s[84:87], 0 offen offset:3064 nt
    s_mov_b64 exec, -1
    s_mov_b64 s[76:77], s[40:41]
    buffer_load_dword v51, v51, s[76:79], 0 offen
    s_branch L_Cm
L_Si:
    v_mov_b32 v8, 0
    v_mov_b32 v9, 0
    v_mov_b32 v10, 0
    v_mov_b32 v11, 0
    v_lshlrev_b32 v7, 2, v0
    v_min_u32 v4, 60, v7
    v_add_u32 v4, 163360, v4
    ds_write_b32 v4, v8
    v_lshlrev_b32 v3, 7, v0
    s_waitcnt lgkmcnt(0)
    s_barrier
    s_cmp_eq_u32 s6, 0
    s_cselect_b64 s[84:85], s[24:25], s[36:37]
    s_cselect_b64 s[56:57], s[16:17], s[28:29]
    s_lshl_b32 s33, s6, 21
    s_add_u32 s33, s33, 17825792
    s_add_u32 s80, s44, s33
    s_addc_u32 s81, s45, 0
    s_mov_b32 s82, 163840
    s_mov_b32 s83, 0x00020000
    s_add_u32 s33, s7, 1
    s_lshl_b32 s33, s33, 15
    s_load_dwordx2 s[22:23], s[80:81], 0
    buffer_load_dword v14, v3, s[80:83], s33 offen
    v_mov_b32 v1, 163360
    v_mov_b32 v2, 1
    s_waitcnt lgkmcnt(0)
    s_and_b32 s27, s22, 0xfffffff0
    s_add_u32 s27, s27, 0x9e3779b0
    v_mov_b32 v4, s27
    s_add_u32 s25, s23, 1
    s_and_b32 s25, s25, 0xffff
    s_add_u32 s8, s25, 0x10000
    v_mov_b32 v5, s8
    ds_write_b64 v1, v[4:5] offset:0
    v_lshlrev_b32 v12, 4, v0
    v_lshlrev_b32 v20, 3, v0
    v_cmp_lt_u32 vcc, 14, v0
    v_add_u32 v20, 126720, v20
    v_add_u32 v21, 4096, v20
    v_cndmask_b32 v20, v20, v21, vcc
    v_add_u32 v16, 74240, v12
    ds_write_b128 v16, v[8:11] offset:0
    ds_write_b128 v16, v[8:11] offset:4640
    ds_write_b128 v16, v[8:11] offset:9280
    ds_write_b128 v16, v[8:11] offset:13920
    s_mov_b32 s86, 2359296
    s_mov_b32 s87, 0x00020000
    s_mov_b64 s[60:61], s[42:43]
    s_mov_b32 s62, 256
    s_mov_b32 s63, 0x00020000
    s_mul_i32 s34, s7, 20
    s_lshl_b32 s8, s6, 7
    s_add_u32 s34, s34, s8
    s_add_u32 s34, s34, 8
    s_mov_b64 s[68:69], s[40:41]
    s_mov_b32 s70, 4718592
    s_mov_b32 s71, 0x00020000
    s_mov_b64 s[72:73], s[40:41]
    s_mov_b32 s74, 4718592
    s_mov_b32 s75, 0x00020000
    s_mov_b32 s12, 0
    s_add_u32 s48, s44, 16777216
    s_addc_u32 s49, s45, 0
    s_mov_b32 s50, 3145728
    s_mov_b32 s51, 0x00020000
    s_mov_b64 s[76:77], s[40:41]
    s_mov_b32 s78, 4718592
    s_mov_b32 s79, 0x00020000
    s_getreg_b32 s26, hwreg(HW_REG_XCC_ID, 0, 4)
    s_add_u32 s26, s26, s27
    s_add_u32 s26, s26, 1
    v_mov_b32 v6, s26
    s_lshl_b32 s22, s7, 5
    s_add_u32 s22, s22, s5
    s_lshr_b32 s22, s22, 1
    s_lshr_b32 s9, s22, 4
    s_lshl_b32 s9, s9, 2
    s_and_b32 s10, s22, 3
    s_add_u32 s19, s9, s10
    s_bfe_u32 s9, s22, 131074
    s_lshl_b32 s9, s9, 6
    s_lshl_b32 s10, s6, 21
    s_add_u32 s23, s9, s10
    s_add_u32 s8, s22, 512
    s_lshl_b32 s8, s8, 12
    v_add_u32 v12, s8, v12
    buffer_load_dwordx4 v[34:37], v12, s[84:87], 0 offen offset:0 nt
    buffer_load_dwordx4 v[42:45], v12, s[84:87], 0 offen offset:1024 nt
    s_mov_b64 exec, 1
    buffer_load_dwordx2 v[40:41], v12, s[84:87], 0 offen offset:1016 nt
    s_mov_b64 exec, -1
    buffer_load_dwordx4 v[50:53], v12, s[84:87], 0 offen offset:2048 nt
    s_mov_b64 exec, 1
    buffer_load_dwordx2 v[48:49], v12, s[84:87], 0 offen offset:2040 nt
    s_mov_b64 exec, -1
    buffer_load_dwordx4 v[58:61], v12, s[84:87], 0 offen offset:3072 nt
    s_mov_b64 exec, 1
    buffer_load_dwordx2 v[56:57], v12, s[84:87], 0 offen offset:3064 nt
    s_mov_b64 exec, -1
    v_lshrrev_b32 v13, 2, v0
    v_sub_u32 v13, 15, v13
    v_add_u32 v4, s19, v13
    v_and_b32 v4, 15, v4
    v_lshl_add_u32 v13, v13, 4, v4
    v_mul_u32_u24 v13, 256, v13
    v_add_u32 v13, s23, v13
    v_and_b32 v4, 3, v0
    v_lshl_add_u32 v13, v4, 4, v13
    v_lshlrev_b32 v18, 3, v0
    v_add_u32 v18, 126720, v18
    s_mov_b32 s47, 0x07060302
    s_setprio 3
    s_waitcnt vmcnt(6)
    v_mov_b32_dpp v32, v36 wave_shr:1 row_mask:0xf bank_mask:0xf bound_ctrl:0
    v_mov_b32_dpp v33, v37 wave_shr:1 row_mask:0xf bank_mask:0xf bound_ctrl:0
    ds_write_b128 v16, v[34:37] offset:14304
    v_alignbit_b32 v96, v33, v32, 16
    v_alignbit_b32 v97, v34, v33, 16
    v_alignbit_b32 v98, v35, v34, 16
    v_alignbit_b32 v99, v36, v35, 16
    ds_write_b128 v16, v[96:99] offset:384
    v_alignbit_b32 v100, v34, v33, 16
    v_alignbit_b32 v101, v35, v34, 16
    v_alignbit_b32 v102, v36, v35, 16
    v_alignbit_b32 v103, v37, v36, 16
    ds_write_b128 v16, v[100:103] offset:9664
    v_pk_mov_b32 v[104:105], v[32:33], v[34:35] op_sel:[1,0]
    v_pk_mov_b32 v[106:107], v[34:35], v[36:37] op_sel:[1,0]
    ds_write_b128 v16, v[104:107] offset:5024
    s_waitcnt vmcnt(4)
    v_mov_b32_dpp v40, v44 wave_shr:1 row_mask:0xf bank_mask:0xf
    v_mov_b32_dpp v41, v45 wave_shr:1 row_mask:0xf bank_mask:0xf
    ds_write_b128 v16, v[42:45] offset:15328
    v_alignbit_b32 v108, v41, v40, 16
    v_alignbit_b32 v109, v42, v41, 16
    v_alignbit_b32 v110, v43, v42, 16
    v_alignbit_b32 v111, v44, v43, 16
    ds_write_b128 v16, v[108:111] offset:1408
    v_alignbit_b32 v112, v42, v41, 16
    v_alignbit_b32 v113, v43, v42, 16
    v_alignbit_b32 v114, v44, v43, 16
    v_alignbit_b32 v115, v45, v44, 16
    ds_write_b128 v16, v[112:115] offset:10688
    v_pk_mov_b32 v[116:117], v[40:41], v[42:43] op_sel:[1,0]
    v_pk_mov_b32 v[118:119], v[42:43], v[44:45] op_sel:[1,0]
    ds_write_b128 v16, v[116:119] offset:6048
    s_waitcnt vmcnt(2)
    v_mov_b32_dpp v48, v52 wave_shr:1 row_mask:0xf bank_mask:0xf
    v_mov_b32_dpp v49, v53 wave_shr:1 row_mask:0xf bank_mask:0xf
    ds_write_b128 v16, v[50:53] offset:16352
    v_alignbit_b32 v96, v49, v48, 16
    v_alignbit_b32 v97, v50, v49, 16
    v_alignbit_b32 v98, v51, v50, 16
    v_alignbit_b32 v99, v52, v51, 16
    ds_write_b128 v16, v[96:99] offset:2432
    v_alignbit_b32 v100, v50, v49, 16
    v_alignbit_b32 v101, v51, v50, 16
    v_alignbit_b32 v102, v52, v51, 16
    v_alignbit_b32 v103, v53, v52, 16
    ds_write_b128 v16, v[100:103] offset:11712
    v_pk_mov_b32 v[104:105], v[48:49], v[50:51] op_sel:[1,0]
    v_pk_mov_b32 v[106:107], v[50:51], v[52:53] op_sel:[1,0]
    ds_write_b128 v16, v[104:107] offset:7072
    s_waitcnt vmcnt(0)
    v_mov_b32_dpp v56, v60 wave_shr:1 row_mask:0xf bank_mask:0xf
    v_mov_b32_dpp v57, v61 wave_shr:1 row_mask:0xf bank_mask:0xf
    ds_write_b128 v16, v[58:61] offset:17376
    v_alignbit_b32 v108, v57, v56, 16
    v_alignbit_b32 v109, v58, v57, 16
    v_alignbit_b32 v110, v59, v58, 16
    v_alignbit_b32 v111, v60, v59, 16
    ds_write_b128 v16, v[108:111] offset:3456
    v_alignbit_b32 v112, v58, v57, 16
    v_alignbit_b32 v113, v59, v58, 16
    v_alignbit_b32 v114, v60, v59, 16
    v_alignbit_b32 v115, v61, v60, 16
    ds_write_b128 v16, v[112:115] offset:12736
    v_pk_mov_b32 v[116:117], v[56:57], v[58:59] op_sel:[1,0]
    v_pk_mov_b32 v[118:119], v[58:59], v[60:61] op_sel:[1,0]
    ds_write_b128 v16, v[116:119] offset:8096
    s_mov_b32 s14, 0
L_pl_1:
    ds_read_b32 v4, v1 offset:8
    s_add_u32 s14, s14, 1
    s_waitcnt lgkmcnt(0)
    v_readfirstlane_b32 s8, v4
    s_cmp_ge_u32 s8, 4
    s_cbranch_scc1 L_pld_2
    s_sleep 1
    s_cmp_lt_u32 s14, 131072
    s_cbranch_scc1 L_pl_1
L_pld_2:
    s_mov_b32 s14, 0
    s_mov_b32 s9, 458752
    buffer_load_dwordx4 v[96:99], v13, s[48:51], s9 offen offset:0 sc1
    s_mov_b32 s9, 393216
    buffer_load_dwordx4 v[100:103], v13, s[48:51], s9 offen offset:0 sc1
    s_mov_b32 s9, 327680
    buffer_load_dwordx4 v[104:107], v13, s[48:51], s9 offen offset:0 sc1
    s_mov_b32 s9, 262144
    buffer_load_dwordx4 v[108:111], v13, s[48:51], s9 offen offset:0 sc1
    s_mov_b32 s9, 196608
    buffer_load_dwordx4 v[112:115], v13, s[48:51], s9 offen offset:0 sc1
    s_mov_b32 s9, 131072
    buffer_load_dwordx4 v[116:119], v13, s[48:51], s9 offen offset:0 sc1
    s_mov_b32 s9, 65536
    buffer_load_dwordx4 v[120:123], v13, s[48:51], s9 offen offset:0 sc1
    buffer_load_dwordx4 v[124:127], v13, s[48:51], 0 offen offset:0 sc1
    s_mov_b64 exec, 1
    ds_add_u32 v1, v2 offset:8
    s_mov_b64 exec, -1
    s_mov_b32 exec_hi, 0
    ds_write_b64 v20, v[8:9] offset:4096
    s_mov_b32 exec_hi, -1
    s_waitcnt vmcnt(0)
L_tl_3:
    v_xor_b32 v4, s25, v96
    v_bitop3_b32 v4, v4, v97, s25 bitop3:0xf6
    v_bitop3_b32 v4, v4, v98, s25 bitop3:0xf6
    v_bitop3_b32 v4, v4, v99, s25 bitop3:0xf6
    v_bitop3_b32 v4, v4, v100, s25 bitop3:0xf6
    v_bitop3_b32 v4, v4, v101, s25 bitop3:0xf6
    v_bitop3_b32 v4, v4, v102, s25 bitop3:0xf6
    v_bitop3_b32 v4, v4, v103, s25 bitop3:0xf6
    v_bitop3_b32 v4, v4, v104, s25 bitop3:0xf6
    v_bitop3_b32 v4, v4, v105, s25 bitop3:0xf6
    v_bitop3_b32 v4, v4, v106, s25 bitop3:0xf6
    v_bitop3_b32 v4, v4, v107, s25 bitop3:0xf6
    v_bitop3_b32 v4, v4, v108, s25 bitop3:0xf6
    v_bitop3_b32 v4, v4, v109, s25 bitop3:0xf6
    v_bitop3_b32 v4, v4, v110, s25 bitop3:0xf6
    v_bitop3_b32 v4, v4, v111, s25 bitop3:0xf6
    v_bitop3_b32 v4, v4, v112, s25 bitop3:0xf6
    v_bitop3_b32 v4, v4, v113, s25 bitop3:0xf6
    v_bitop3_b32 v4, v4, v114, s25 bitop3:0xf6
    v_bitop3_b32 v4, v4, v115, s25 bitop3:0xf6
    v_bitop3_b32 v4, v4, v116, s25 bitop3:0xf6
    v_bitop3_b32 v4, v4, v117, s25 bitop3:0xf6
    v_bitop3_b32 v4, v4, v118, s25 bitop3:0xf6
    v_bitop3_b32 v4, v4, v119, s25 bitop3:0xf6
    v_bitop3_b32 v4, v4, v120, s25 bitop3:0xf6
    v_bitop3_b32 v4, v4, v121, s25 bitop3:0xf6
    v_bitop3_b32 v4, v4, v122, s25 bitop3:0xf6
    v_bitop3_b32 v4, v4, v123, s25 bitop3:0xf6
    v_bitop3_b32 v4, v4, v124, s25 bitop3:0xf6
    v_bitop3_b32 v4, v4, v125, s25 bitop3:0xf6
    v_bitop3_b32 v4, v4, v126, s25 bitop3:0xf6
    v_bitop3_b32 v4, v4, v127, s25 bitop3:0xf6
    v_and_b32 v4, 0xffff, v4
    v_cmp_ne_u32 vcc, 0, v4
    s_cbranch_vccnz L_tlc_5
L_tld_4:
    v_perm_b32 v64, v97, v96, s47
    v_perm_b32 v65, v99, v98, s47
    ds_write_b64 v18, v[64:65] offset:0
    ds_write_b64 v18, v[64:65] offset:4216
    v_perm_b32 v66, v101, v100, s47
    v_perm_b32 v67, v103, v102, s47
    ds_write_b64 v18, v[66:67] offset:512
    ds_write_b64 v18, v[66:67] offset:4728
    v_perm_b32 v68, v105, v104, s47
    v_perm_b32 v69, v107, v106, s47
    ds_write_b64 v18, v[68:69] offset:1024
    ds_write_b64 v18, v[68:69] offset:5240
    v_perm_b32 v70, v109, v108, s47
    v_perm_b32 v71, v111, v110, s47
    ds_write_b64 v18, v[70:71] offset:1536
    ds_write_b64 v18, v[70:71] offset:5752
    v_perm_b32 v72, v113, v112, s47
    v_perm_b32 v73, v115, v114, s47
    ds_write_b64 v18, v[72:73] offset:2048
    ds_write_b64 v18, v[72:73] offset:6264
    v_perm_b32 v74, v117, v116, s47
    v_perm_b32 v75, v119, v118, s47
    ds_write_b64 v18, v[74:75] offset:2560
    ds_write_b64 v18, v[74:75] offset:6776
    v_perm_b32 v76, v121, v120, s47
    v_perm_b32 v77, v123, v122, s47
    ds_write_b64 v18, v[76:77] offset:3072
    ds_write_b64 v18, v[76:77] offset:7288
    v_perm_b32 v78, v125, v124, s47
    v_perm_b32 v79, v127, v126, s47
    ds_write_b64 v18, v[78:79] offset:3584
    ds_write_b64 v18, v[78:79] offset:7800
    s_waitcnt lgkmcnt(0)
    s_mov_b64 exec, 1
    ds_add_u32 v1, v2 offset:32
    s_mov_b64 exec, -1
    s_or_b32 s8, s7, s5
    s_cbranch_scc1 L_epo_6
    s_mov_b64 exec, 1
    v_mov_b32 v4, s27
    v_mov_b32 v5, s25
    buffer_store_dwordx2 v[4:5], off, s[80:83], 0
    s_mov_b64 exec, -1
L_epo_6:
    s_endpgm
L_tlc_5:
    s_add_u32 s14, s14, 1
    s_cmp_lt_u32 s14, 32768
    s_cbranch_scc0 L_tld_4
    s_and_b32 s8, s14, 63
    s_cbranch_scc1 L_tlr_7
    buffer_inv sc1
L_tlr_7:
    s_sleep 2
    s_mov_b32 s9, 458752
    buffer_load_dwordx4 v[96:99], v13, s[48:51], s9 offen offset:0 sc1
    s_mov_b32 s9, 393216
    buffer_load_dwordx4 v[100:103], v13, s[48:51], s9 offen offset:0 sc1
    s_mov_b32 s9, 327680
    buffer_load_dwordx4 v[104:107], v13, s[48:51], s9 offen offset:0 sc1
    s_mov_b32 s9, 262144
    buffer_load_dwordx4 v[108:111], v13, s[48:51], s9 offen offset:0 sc1
    s_mov_b32 s9, 196608
    buffer_load_dwordx4 v[112:115], v13, s[48:51], s9 offen offset:0 sc1
    s_mov_b32 s9, 131072
    buffer_load_dwordx4 v[116:119], v13, s[48:51], s9 offen offset:0 sc1
    s_mov_b32 s9, 65536
    buffer_load_dwordx4 v[120:123], v13, s[48:51], s9 offen offset:0 sc1
    buffer_load_dwordx4 v[124:127], v13, s[48:51], 0 offen offset:0 sc1
    s_waitcnt vmcnt(0)
    s_branch L_tl_3
L_Em:
    s_setprio 1
    s_cmp_eq_u32 s100, 8
    s_cbranch_scc0 L_Eh
    s_setprio 3
L_Eh:
    v_and_b32 v5, 15, v0
    v_lshrrev_b32 v6, 4, v0
    v_mul_u32_u24 v1, 4608, v6
    v_lshl_add_u32 v1, v5, 3, v1
    v_add_u32 v1, s15, v1
    s_cbranch_vccz L_e2a_13
    s_sub_u32 s101, s100, 4
    s_mul_i32 s101, s101, 4480
    s_add_u32 s101, s101, 145440
    s_mov_b32 s66, 1152
    s_mov_b32 s67, 0x00020000
    s_lshl_b32 s8, s46, 9
    v_lshl_add_u32 v3, v5, 5, s8
    s_lshl_b32 s8, s46, 7
    v_lshl_add_u32 v4, v5, 3, s8
    buffer_load_dwordx4 v[16:19], v3, s[60:63], 0 offen
    buffer_load_dwordx4 v[20:23], v3, s[60:63], 0 offen offset:16
    buffer_load_dwordx2 v[24:25], v4, s[64:67], 0 offen
L_e2a_13:
    v_lshlrev_b32 v126, 9, v6
    v_lshl_add_u32 v126, v5, 3, v126
    v_add_u32 v126, s101, v126
    v_lshl_add_u32 v3, v5, 5, s101
    v_lshl_add_u32 v4, v5, 3, s101
    s_mov_b32 s58, 2359296
    s_mov_b32 s59, 0x00020000
    s_mov_b32 s86, 2359296
    s_mov_b32 s87, 0x00020000
    s_mov_b64 s[76:77], s[40:41]
    s_mov_b32 s78, 4718592
    s_mov_b32 s79, 0x00020000
    s_lshl_b32 s33, s6, 21
    s_add_u32 s33, s33, 17825792
    s_add_u32 s80, s44, s33
    s_addc_u32 s81, s45, 0
    s_mov_b32 s82, 163840
    s_mov_b32 s83, 0x00020000
    s_add_u32 s33, s7, 1
    s_lshl_b32 s33, s33, 15
    s_mov_b64 s[60:61], s[42:43]
    s_mov_b32 s62, 256
    s_mov_b32 s63, 0x00020000
    s_mul_i32 s34, s7, 20
    s_lshl_b32 s8, s6, 7
    s_add_u32 s34, s34, s8
    s_add_u32 s34, s34, 8
    s_mov_b64 s[68:69], s[40:41]
    s_mov_b32 s70, 4718592
    s_mov_b32 s71, 0x00020000
    s_mov_b64 s[72:73], s[40:41]
    s_mov_b32 s74, 4718592
    s_mov_b32 s75, 0x00020000
    s_mov_b32 s12, 0
    s_mov_b32 s17, s46
    s_lshl_b32 s16, s47, 4
    s_lshl_b32 s9, s17, 7
    s_mul_i32 s18, s6, 1152
    s_add_u32 s18, s18, s9
    s_mul_i32 s8, s16, 2304
    s_add_u32 s8, s8, s18
    v_mul_u32_u24 v10, 9216, v6
    v_lshl_add_u32 v10, v5, 3, v10
    v_add_u32 v10, s8, v10
    v_add_u32 v11, 4608, v10
    s_lshl_b32 s9, s47, 12
    s_lshl_b32 s10, s6, 21
    s_add_u32 s9, s9, s10
    s_mov_b32 s10, 2304
    s_cmp_eq_u32 s100, 8
    s_cselect_b32 s8, s9, s8
    s_cselect_b32 s9, 256, s10
    s_cselect_b32 s10, 6, 5
    v_and_b32 v9, 12, v5
    v_add3_u32 v9, v9, v6, s47
    v_and_b32 v9, 15, v9
    v_mul_u32_u24 v9, s9, v9
    v_and_b32 v12, 3, v5
    v_lshlrev_b32 v12, s10, v12
    v_add3_u32 v9, v9, v12, s8
    v_mov_b32 v7, 163360
    v_mov_b32 v8, 1
    v_lshlrev_b32 v15, 3, v0
    v_lshlrev_b32 v124, 9, v0
    s_and_b32 s23, s100, 3
    s_lshl_b32 s13, s5, 2
    s_add_u32 s13, s13, s23
    s_lshl_b32 s13, s13, 2
    s_add_u32 s13, s13, s33
    s_mov_b32 s47, 0xffff0000
    s_getreg_b32 s26, hwreg(HW_REG_XCC_ID, 0, 4)
    s_mov_b32 s14, 0
L_gn_14:
    ds_read_b64 v[12:13], v7 offset:0
    s_add_u32 s14, s14, 1
    s_waitcnt lgkmcnt(0)
    v_readfirstlane_b32 s25, v13
    v_readfirstlane_b32 s27, v12
    s_cmp_ge_u32 s25, 1
    s_cbranch_scc1 L_gnd_15
    s_sleep 1
    s_cmp_lt_u32 s14, 131072
    s_cbranch_scc1 L_gn_14
L_gnd_15:
    s_add_u32 s26, s26, s27
    s_add_u32 s26, s26, 1
    v_mov_b32 v14, s26
    s_and_b32 s25, s25, 0xffff
    s_cbranch_vccnz L_e2_10
    s_waitcnt vmcnt(2)
    ds_read_b128 v[16:19], v3 offset:4480
    ds_read_b128 v[20:23], v3 offset:4496
    ds_read_b64 v[26:27], v126 offset:0
    ds_read_b64 v[28:29], v126 offset:128
    ds_read_b64 v[30:31], v126 offset:256
    ds_read_b64 v[32:33], v126 offset:384
    ds_read_b64 v[34:35], v126 offset:512
    ds_read_b64 v[36:37], v126 offset:640
    ds_read_b64 v[38:39], v126 offset:768
    ds_read_b64 v[24:25], v4 offset:4992
    s_waitcnt lgkmcnt(8)
    v_lshlrev_b32 v56, 16, v16
    v_and_b32 v60, s47, v16
    v_lshlrev_b32 v64, 16, v17
    v_and_b32 v68, s47, v17
    v_lshlrev_b32 v57, 16, v18
    v_and_b32 v61, s47, v18
    v_lshlrev_b32 v65, 16, v19
    v_and_b32 v69, s47, v19
    v_lshlrev_b32 v58, 16, v20
    v_and_b32 v62, s47, v20
    v_lshlrev_b32 v66, 16, v21
    v_and_b32 v70, s47, v21
    v_lshlrev_b32 v59, 16, v22
    v_and_b32 v63, s47, v22
    v_lshlrev_b32 v67, 16, v23
    v_and_b32 v71, s47, v23
    s_waitcnt lgkmcnt(0)
    v_lshlrev_b32 v72, 16, v26
    v_and_b32 v73, s47, v26
    v_lshlrev_b32 v74, 16, v27
    v_and_b32 v75, s47, v27
    v_lshlrev_b32 v76, 16, v28
    v_and_b32 v77, s47, v28
    v_lshlrev_b32 v78, 16, v29
    v_and_b32 v79, s47, v29
    v_lshlrev_b32 v80, 16, v30
    v_and_b32 v81, s47, v30
    v_lshlrev_b32 v82, 16, v31
    v_and_b32 v83, s47, v31
    v_lshlrev_b32 v84, 16, v32
    v_and_b32 v85, s47, v32
    v_lshlrev_b32 v86, 16, v33
    v_and_b32 v87, s47, v33
    v_lshlrev_b32 v88, 16, v34
    v_and_b32 v89, s47, v34
    v_lshlrev_b32 v90, 16, v35
    v_and_b32 v91, s47, v35
    v_lshlrev_b32 v92, 16, v36
    v_and_b32 v93, s47, v36
    v_lshlrev_b32 v94, 16, v37
    v_and_b32 v95, s47, v37
    v_lshlrev_b32 v96, 16, v38
    v_and_b32 v97, s47, v38
    v_lshlrev_b32 v98, 16, v39
    v_and_b32 v99, s47, v39
    v_pk_mul_f32 v[100:101], v[72:73], v[68:69]
    v_pk_mul_f32 v[102:103], v[74:75], v[70:71]
    v_pk_mul_f32 v[104:105], v[76:77], v[68:69]
    v_pk_mul_f32 v[106:107], v[78:79], v[70:71]
    v_pk_mul_f32 v[108:109], v[80:81], v[68:69]
    v_pk_mul_f32 v[110:111], v[82:83], v[70:71]
    v_pk_mul_f32 v[112:113], v[84:85], v[68:69]
    v_pk_mul_f32 v[114:115], v[86:87], v[70:71]
    v_pk_fma_f32 v[100:101], v[76:77], v[64:65], v[100:101]
    v_pk_fma_f32 v[102:103], v[78:79], v[66:67], v[102:103]
    v_pk_fma_f32 v[104:105], v[80:81], v[64:65], v[104:105]
    v_pk_fma_f32 v[106:107], v[82:83], v[66:67], v[106:107]
    v_pk_fma_f32 v[108:109], v[84:85], v[64:65], v[108:109]
    v_pk_fma_f32 v[110:111], v[86:87], v[66:67], v[110:111]
    v_pk_fma_f32 v[112:113], v[88:89], v[64:65], v[112:113]
    v_pk_fma_f32 v[114:115], v[90:91], v[66:67], v[114:115]
    v_pk_fma_f32 v[100:101], v[80:81], v[60:61], v[100:101]
    v_pk_fma_f32 v[102:103], v[82:83], v[62:63], v[102:103]
    v_pk_fma_f32 v[104:105], v[84:85], v[60:61], v[104:105]
    v_pk_fma_f32 v[106:107], v[86:87], v[62:63], v[106:107]
    v_pk_fma_f32 v[108:109], v[88:89], v[60:61], v[108:109]
    v_pk_fma_f32 v[110:111], v[90:91], v[62:63], v[110:111]
    v_pk_fma_f32 v[112:113], v[92:93], v[60:61], v[112:113]
    v_pk_fma_f32 v[114:115], v[94:95], v[62:63], v[114:115]
    s_waitcnt vmcnt(0)
    ds_read_b64 v[40:41], v126 offset:2432
    ds_read_b64 v[42:43], v126 offset:2560
    ds_read_b64 v[44:45], v126 offset:2688
    ds_read_b64 v[46:47], v126 offset:2816
    v_pk_fma_f32 v[100:101], v[84:85], v[56:57], v[100:101]
    v_pk_fma_f32 v[102:103], v[86:87], v[58:59], v[102:103]
    v_pk_fma_f32 v[104:105], v[88:89], v[56:57], v[104:105]
    v_pk_fma_f32 v[106:107], v[90:91], v[58:59], v[106:107]
    v_pk_fma_f32 v[108:109], v[92:93], v[56:57], v[108:109]
    v_pk_fma_f32 v[110:111], v[94:95], v[58:59], v[110:111]
    v_pk_fma_f32 v[112:113], v[96:97], v[56:57], v[112:113]
    v_pk_fma_f32 v[114:115], v[98:99], v[58:59], v[114:115]
    s_waitcnt lgkmcnt(0)
    v_lshlrev_b32 v72, 16, v40
    v_and_b32 v73, s47, v40
    v_lshlrev_b32 v74, 16, v41
    v_and_b32 v75, s47, v41
    v_lshlrev_b32 v76, 16, v42
    v_and_b32 v77, s47, v42
    v_lshlrev_b32 v78, 16, v43
    v_and_b32 v79, s47, v43
    v_lshlrev_b32 v80, 16, v44
    v_and_b32 v81, s47, v44
    v_lshlrev_b32 v82, 16, v45
    v_and_b32 v83, s47, v45
    v_lshlrev_b32 v84, 16, v46
    v_and_b32 v85, s47, v46
    v_lshlrev_b32 v86, 16, v47
    v_and_b32 v87, s47, v47
    v_pk_mul_f32 v[100:101], v[100:101], v[72:73]
    v_pk_mul_f32 v[102:103], v[102:103], v[74:75]
    v_pk_mul_f32 v[104:105], v[104:105], v[76:77]
    v_pk_mul_f32 v[106:107], v[106:107], v[78:79]
    v_pk_mul_f32 v[108:109], v[108:109], v[80:81]
    v_pk_mul_f32 v[110:111], v[110:111], v[82:83]
    v_pk_mul_f32 v[112:113], v[112:113], v[84:85]
    v_pk_mul_f32 v[114:115], v[114:115], v[86:87]
    v_cvt_pk_bf16_f32 v122, v112, v108
    v_cvt_pk_bf16_f32 v123, v104, v100
    v_cvt_pk_bf16_f32 v120, v113, v109
    v_cvt_pk_bf16_f32 v121, v105, v101
    v_cvt_pk_bf16_f32 v118, v114, v110
    v_cvt_pk_bf16_f32 v119, v106, v102
    v_cvt_pk_bf16_f32 v116, v115, v111
    v_cvt_pk_bf16_f32 v117, v107, v103
    s_nop 1
    v_permlane32_swap_b32 v122, v118
    v_permlane32_swap_b32 v123, v119
    v_permlane32_swap_b32 v120, v116
    v_permlane32_swap_b32 v121, v117
    s_nop 1
    v_permlane16_swap_b32 v122, v120
    v_permlane16_swap_b32 v123, v121
    v_permlane16_swap_b32 v118, v116
    v_permlane16_swap_b32 v119, v117
    s_cmp_eq_u32 s100, 8
    s_cbranch_scc1 L_ex_8
    buffer_store_dwordx4 v[116:119], v9, s[68:71], 0 offen
    buffer_store_dwordx4 v[120:123], v9, s[68:71], 0 offen offset:16
    v_lshlrev_b32 v56, 16, v24
    v_and_b32 v57, s47, v24
    v_lshlrev_b32 v58, 16, v25
    v_and_b32 v59, s47, v25
    v_pk_mul_f32 v[100:101], v[100:101], v[56:57]
    v_pk_mul_f32 v[102:103], v[102:103], v[58:59]
    v_pk_mul_f32 v[104:105], v[104:105], v[56:57]
    v_pk_mul_f32 v[106:107], v[106:107], v[58:59]
    v_pk_mul_f32 v[108:109], v[108:109], v[56:57]
    v_pk_mul_f32 v[110:111], v[110:111], v[58:59]
    v_pk_mul_f32 v[112:113], v[112:113], v[56:57]
    v_pk_mul_f32 v[114:115], v[114:115], v[58:59]
L_ep_9:
    s_waitcnt vmcnt(0)
    s_mov_b64 exec, 15
    s_cmp_eq_u32 s12, 0
    s_cbranch_scc0 L_ma_16
    buffer_store_dword v14, v124, s[80:83], s13 offen
L_mb_17:
    s_mov_b64 exec, -1
    s_and_b32 s9, s5, 12
    s_add_u32 s9, s9, s100
    s_lshl_b32 s9, s9, 2
    s_and_b32 s10, s5, 3
    s_add_u32 s9, s9, s10
    s_lshr_b32 s10, s5, 4
    s_lshl_b32 s11, s7, 1
    s_add_u32 s10, s10, s11
    s_lshl_b32 s10, s10, 6
    s_add_u32 s8, s9, s10
    s_lshl_b32 s8, s8, 12
    v_lshl_add_u32 v4, v0, 4, s8
    s_mul_i32 s8, s100, 18560
    v_lshl_add_u32 v126, v0, 4, s8
    s_lshr_b32 s10, s5, 4
    s_lshl_b32 s11, s7, 1
    s_add_u32 s10, s10, s11
    s_lshl_b32 s10, s10, 7
    s_mul_i32 s21, s6, 1152
    s_add_u32 s21, s21, s10
    s_and_b32 s22, s5, 15
    v_lshrrev_b32 v2, 3, v0
    v_add_u32 v12, s22, v2
    v_and_b32 v12, 15, v12
    v_lshl_add_u32 v2, v2, 4, v12
    v_mul_u32_u24 v2, 2304, v2
    v_add_u32 v2, s21, v2
    v_lshrrev_b32 v3, 3, v0
    v_add_u32 v3, 8, v3
    v_add_u32 v12, s22, v3
    v_and_b32 v12, 15, v12
    v_lshl_add_u32 v3, v3, 4, v12
    v_mul_u32_u24 v3, 2304, v3
    v_add_u32 v3, s21, v3
    v_and_b32 v12, 7, v0
    v_lshl_add_u32 v2, v12, 4, v2
    v_lshl_add_u32 v3, v12, 4, v3
    s_lshl_b32 s8, s100, 4
    s_add_u32 s8, s8, 64
    v_lshrrev_b32 v45, 2, v0
    v_add_u32 v45, s8, v45
    v_add_u32 v12, s22, v45
    v_and_b32 v12, 15, v12
    v_lshl_add_u32 v45, v45, 4, v12
    v_mul_u32_u24 v45, 2304, v45
    v_add_u32 v45, s21, v45
    s_lshl_b32 s8, s100, 4
    s_sub_u32 s8, 127, s8
    v_lshrrev_b32 v40, 3, v0
    v_sub_u32 v125, s8, v40
    v_add_u32 v127, -8, v125
    v_add_u32 v12, s22, v125
    v_and_b32 v12, 15, v12
    v_lshl_add_u32 v125, v125, 4, v12
    v_mul_u32_u24 v125, 2304, v125
    v_add_u32 v125, s21, v125
    v_add_u32 v12, s22, v127
    v_and_b32 v12, 15, v12
    v_lshl_add_u32 v127, v127, 4, v12
    v_mul_u32_u24 v127, 2304, v127
    v_add_u32 v127, s21, v127
    v_and_b32 v12, 7, v0
    v_lshl_add_u32 v125, v12, 4, v125
    v_lshl_add_u32 v127, v12, 4, v127
    s_lshl_b32 s8, s100, 9
    s_add_u32 s8, s8, 92800
    v_lshl_add_u32 v40, v40, 5, s8
    v_lshrrev_b32 v12, 1, v12
    v_mul_u32_u24 v12, 8480, v12
    v_add_u32 v40, v40, v12
    v_and_b32 v12, 1, v0
    v_lshl_add_u32 v40, v12, 4, v40
    v_add_u32 v41, 4216, v40
    s_lshl_b32 s8, s100, 11
    s_add_u32 s8, s8, 135200
    v_lshl_add_u32 v5, v0, 4, s8
    s_mul_i32 s21, s100, 589824
    s_add_u32 s28, s44, 17301504
    s_addc_u32 s29, s45, 0
    s_mov_b32 s30, 3145728
    s_mov_b32 s31, 0x00020000
    s_lshl_b32 s8, s7, 5
    s_add_u32 s8, s8, s5
    s_lshr_b32 s8, s8, 1
    s_lshl_b32 s24, s6, 21
    v_lshrrev_b32 v42, 3, v0
    v_add_u32 v12, s8, v42
    v_and_b32 v12, 7, v12
    s_and_b32 s8, s8, 56
    v_or_b32 v12, s8, v12
    v_lshl_add_u32 v42, v42, 6, v12
    v_lshlrev_b32 v42, 7, v42
    v_and_b32 v12, 7, v0
    v_lshl_add_u32 v42, v12, 4, v42
    v_add_u32 v42, s24, v42
    s_lshl_b32 s8, s23, 12
    s_add_u32 s8, s8, 145440
    v_lshl_add_u32 v43, v0, 4, s8
    v_mov_b32 v44, s25
    s_mov_b32 s8, 0x7430
    s_mov_b32 s9, 0x6521
    s_and_b32 s10, s5, 1
    s_cselect_b32 s8, s9, s8
    s_lshl_b32 s9, s23, 2
    s_lshr_b32 s8, s8, s9
    s_and_b32 s8, s8, 7
    s_lshl_b32 s24, s8, 16
    s_mov_b32 s14, 0
L_pl_18:
    ds_read_b64 v[12:13], v7 offset:8
    s_add_u32 s14, s14, 1
    s_waitcnt lgkmcnt(0)
    v_readfirstlane_b32 s8, v12
    v_readfirstlane_b32 s22, v13
    s_cmp_gt_u32 s22, s12
    s_cbranch_scc1 L_rp_20
    s_cmp_ge_u32 s8, 9
    s_cbranch_scc1 L_pld_19
    s_sleep 1
    s_cmp_lt_u32 s14, 131072
    s_cbranch_scc1 L_pl_18
L_pld_19:
    buffer_load_dword v45, v45, s[76:79], 0 offen
    s_setprio 3
    s_add_u32 s13, s13, 4096
    s_lshl_b32 s8, s100, 9
    s_add_u32 s22, s8, s33
    s_add_u32 s22, s22, 2048
    s_mov_b32 s14, 0
L_pl_21:
    ds_read_b32 v12, v7 offset:44
    s_add_u32 s14, s14, 1
    s_waitcnt lgkmcnt(0)
    v_readfirstlane_b32 s8, v12
    s_cmp_ge_u32 s8, 4
    s_cbranch_scc1 L_pld_22
    s_sleep 2
    s_cmp_lt_u32 s14, 131072
    s_cbranch_scc1 L_pl_21
L_pld_22:
    ds_read_b128 v[56:59], v43 offset:0
    ds_read_b128 v[60:63], v43 offset:1024
    ds_read_b128 v[64:67], v43 offset:2048
    ds_read_b128 v[68:71], v43 offset:3072
    s_waitcnt lgkmcnt(2)
    v_add_f32 v56, v56, v60
    v_add_f32 v57, v57, v61
    v_add_f32 v58, v58, v62
    v_add_f32 v59, v59, v63
    s_waitcnt lgkmcnt(0)
    v_add_f32 v64, v64, v68
    v_add_f32 v65, v65, v69
    v_add_f32 v66, v66, v70
    v_add_f32 v67, v67, v71
    v_add_f32 v56, v56, v64
    v_add_f32 v57, v57, v65
    v_add_f32 v58, v58, v66
    v_add_f32 v59, v59, v67
    v_cvt_pk_bf16_f32 v60, v56, v57
    v_cvt_pk_bf16_f32 v61, v58, v59
    v_lshl_or_b32 v72, v60, 16, v44
    v_and_or_b32 v73, v60, s47, v44
    v_lshl_or_b32 v74, v61, 16, v44
    v_and_or_b32 v75, v61, s47, v44
    s_mov_b32 s14, 0
L_pg_24:
    buffer_load_dwordx2 v[12:13], v15, s[80:83], s22 offen sc1
    s_add_u32 s14, s14, 1
    s_waitcnt vmcnt(0)
    v_xor_b32 v12, s26, v12
    v_bitop3_b32 v12, v12, v13, s26 bitop3:0xf6
    v_cmp_ne_u32 vcc, 0, v12
    s_cbranch_vccz L_pgd_25
    s_sleep 1
    s_and_b32 s8, s14, 63
    s_cbranch_scc1 L_pg_24
    s_branch L_pgc_26
L_pgd_25:
    buffer_load_dwordx4 v[28:31], v125, s[68:71], 0 offen sc1
    buffer_load_dwordx4 v[32:35], v127, s[68:71], 0 offen sc1
L_ug_23:
    s_waitcnt vmcnt(1)
    ds_write_b128 v40, v[28:31] offset:0
    ds_write2_b64 v41, v[28:29], v[30:31] offset0:0 offset1:1
    s_waitcnt vmcnt(0)
    ds_write_b128 v40, v[32:35] offset:256
    ds_write2_b64 v41, v[32:33], v[34:35] offset0:32 offset1:33
    buffer_store_dwordx4 v[72:75], v42, s[28:31], s24 offen sc1
    s_waitcnt lgkmcnt(0)
    s_mov_b64 exec, 1
    ds_add_u32 v7, v8 offset:36
    s_mov_b64 exec, -1
    buffer_load_dwordx2 v[48:49], v1, s[56:59], 0 offen offset:0 nt
    buffer_load_dwordx2 v[50:51], v1, s[56:59], 0 offen offset:1152 nt
    buffer_load_dwordx2 v[52:53], v1, s[56:59], 0 offen offset:2304 nt
    buffer_load_dwordx2 v[54:55], v1, s[56:59], 0 offen offset:3456 nt
    s_waitcnt vmcnt(4)
    s_mov_b64 exec, 1
    ds_add_u32 v7, v8 offset:56
    s_mov_b64 exec, -1
    s_setprio 0
    s_waitcnt vmcnt(0)
    v_lshlrev_b32 v72, 16, v48
    v_and_b32 v73, s47, v48
    v_lshlrev_b32 v74, 16, v49
    v_and_b32 v75, s47, v49
    v_lshlrev_b32 v76, 16, v50
    v_and_b32 v77, s47, v50
    v_lshlrev_b32 v78, 16, v51
    v_and_b32 v79, s47, v51
    v_lshlrev_b32 v80, 16, v52
    v_and_b32 v81, s47, v52
    v_lshlrev_b32 v82, 16, v53
    v_and_b32 v83, s47, v53
    v_lshlrev_b32 v84, 16, v54
    v_and_b32 v85, s47, v54
    v_lshlrev_b32 v86, 16, v55
    v_and_b32 v87, s47, v55
    v_mul_f32 v100, v100, v72
    v_mul_f32 v101, v101, v73
    v_mul_f32 v102, v102, v74
    v_mul_f32 v103, v103, v75
    v_mul_f32 v104, v104, v76
    v_mul_f32 v105, v105, v77
    v_mul_f32 v106, v106, v78
    v_mul_f32 v107, v107, v79
    v_mul_f32 v108, v108, v80
    v_mul_f32 v109, v109, v81
    v_mul_f32 v110, v110, v82
    v_mul_f32 v111, v111, v83
    v_mul_f32 v112, v112, v84
    v_mul_f32 v113, v113, v85
    v_mul_f32 v114, v114, v86
    v_mul_f32 v115, v115, v87
    s_lshl_b32 s8, s23, 9
    s_add_u32 s22, s8, s33
    s_add_u32 s22, s22, 4096
    s_mov_b32 s14, 0
L_pg_29:
    buffer_load_dwordx2 v[12:13], v15, s[80:83], s22 offen sc1
    s_add_u32 s14, s14, 1
    s_waitcnt vmcnt(0)
    v_xor_b32 v12, s26, v12
    v_bitop3_b32 v12, v12, v13, s26 bitop3:0xf6
    v_cmp_ne_u32 vcc, 0, v12
    s_cbranch_vccz L_pgd_30
    s_sleep 2
    s_and_b32 s8, s14, 63
    s_cbranch_scc1 L_pg_29
    s_branch L_pgc_31
L_pgd_30:
    buffer_load_dwordx4 v[16:19], v9, s[72:75], 0 offen sc1
    buffer_load_dwordx4 v[20:23], v9, s[72:75], 0 offen offset:16 sc1
    s_waitcnt vmcnt(0)
L_yg_28:
L_ez_121:
    s_nop 1
    v_permlane32_swap_b32 v16, v20
    v_permlane32_swap_b32 v17, v21
    v_permlane32_swap_b32 v18, v22
    v_permlane32_swap_b32 v19, v23
    s_nop 1
    v_permlane16_swap_b32 v16, v18
    v_permlane16_swap_b32 v17, v19
    v_permlane16_swap_b32 v20, v22
    v_permlane16_swap_b32 v21, v23
L_ez_122:
    v_lshlrev_b32 v24, 16, v16
    v_and_b32 v28, s47, v16
    v_lshlrev_b32 v32, 16, v17
    v_and_b32 v36, s47, v17
    v_lshlrev_b32 v25, 16, v18
    v_and_b32 v29, s47, v18
    v_lshlrev_b32 v33, 16, v19
    v_and_b32 v37, s47, v19
    v_lshlrev_b32 v26, 16, v20
    v_and_b32 v30, s47, v20
    v_lshlrev_b32 v34, 16, v21
    v_and_b32 v38, s47, v21
    v_lshlrev_b32 v27, 16, v22
    v_and_b32 v31, s47, v22
    v_lshlrev_b32 v35, 16, v23
    v_and_b32 v39, s47, v23
    v_fma_f32 v24, v72, v24, v100
    v_fma_f32 v25, v73, v25, v101
    v_fma_f32 v26, v74, v26, v102
    v_fma_f32 v27, v75, v27, v103
    v_cvt_pk_bf16_f32 v16, v24, v25
    v_cvt_pk_bf16_f32 v17, v26, v27
    buffer_store_dwordx2 v[16:17], v10, s[76:79], 0 offen offset:0
    v_fma_f32 v28, v76, v28, v104
    v_fma_f32 v29, v77, v29, v105
    v_fma_f32 v30, v78, v30, v106
    v_fma_f32 v31, v79, v31, v107
    v_cvt_pk_bf16_f32 v18, v28, v29
    v_cvt_pk_bf16_f32 v19, v30, v31
    buffer_store_dwordx2 v[18:19], v10, s[76:79], 0 offen offset:2304
    v_fma_f32 v32, v80, v32, v108
    v_fma_f32 v33, v81, v33, v109
    v_fma_f32 v34, v82, v34, v110
    v_fma_f32 v35, v83, v35, v111
    v_cvt_pk_bf16_f32 v20, v32, v33
    v_cvt_pk_bf16_f32 v21, v34, v35
    buffer_store_dwordx2 v[20:21], v11, s[76:79], 0 offen offset:0
    v_fma_f32 v36, v84, v36, v112
    v_fma_f32 v37, v85, v37, v113
    v_fma_f32 v38, v86, v38, v114
    v_fma_f32 v39, v87, v39, v115
    v_cvt_pk_bf16_f32 v22, v36, v37
    v_cvt_pk_bf16_f32 v23, v38, v39
    buffer_store_dwordx2 v[22:23], v11, s[76:79], 0 offen offset:2304
    s_endpgm
L_ma_16:
    s_mov_b64 exec, 1
    v_mov_b32 v16, 1
    buffer_atomic_add v16, off, s[60:63], s34 offset:4 sc0 sc1
    s_waitcnt vmcnt(0)
    v_readfirstlane_b32 s8, v16
    s_cmp_eq_u32 s8, 127
    s_cbranch_scc0 L_mb_17
    s_mov_b64 exec, -1
    s_add_u32 s9, s33, 0
    v_lshlrev_b32 v20, 4, v0
    v_mov_b32 v16, v14
    v_mov_b32 v17, v14
    v_mov_b32 v18, v14
    v_mov_b32 v19, v14
    buffer_store_dwordx4 v[16:19], v20, s[80:83], s9 offen offset:0 sc1
    buffer_store_dwordx4 v[16:19], v20, s[80:83], s9 offen offset:1024 sc1
    buffer_store_dwordx4 v[16:19], v20, s[80:83], s9 offen offset:0
    buffer_store_dwordx4 v[16:19], v20, s[80:83], s9 offen offset:1024
    s_branch L_mb_17
L_rp_20:
    s_mov_b32 s12, 1
    s_mov_b32 s26, s27
    v_mov_b32 v14, s27
    s_add_u32 s33, s33, 16384
    s_mov_b64 s[68:69], s[44:45]
    s_add_u32 s72, s44, 4718592
    s_addc_u32 s73, s45, 0
    buffer_store_dwordx4 v[116:119], v9, s[68:71], 0 offen sc1
    buffer_store_dwordx4 v[120:123], v9, s[68:71], 0 offen offset:16 sc1
    s_branch L_ep_9
L_pgc_26:
    s_cmp_eq_u32 s12, 0
    s_cbranch_scc1 L_pgr_27
    s_mov_b64 exec, 1
    v_mov_b32 v12, 0
    buffer_atomic_add v12, off, s[60:63], s34 offset:16 sc0 sc1
    s_waitcnt vmcnt(0)
    v_readfirstlane_b32 s8, v12
    s_mov_b64 exec, -1
    s_cmp_ge_u32 s8, 128
    s_cbranch_scc1 L_pgd_25
L_pgr_27:
    s_cmp_lt_u32 s14, 32768
    s_cbranch_scc1 L_pg_24
    s_branch L_pgd_25
L_pgc_31:
    s_cmp_eq_u32 s12, 0
    s_cbranch_scc1 L_pgr_32
    s_mov_b64 exec, 1
    v_mov_b32 v12, 0
    buffer_atomic_add v12, off, s[60:63], s34 offset:8 sc0 sc1
    s_waitcnt vmcnt(0)
    v_readfirstlane_b32 s8, v12
    s_mov_b64 exec, -1
    s_cmp_ge_u32 s8, 128
    s_cbranch_scc1 L_pgd_30
L_pgr_32:
    s_cmp_lt_u32 s14, 32768
    s_cbranch_scc1 L_pg_29
    s_branch L_pgd_30
L_e2_10:
    v_lshrrev_b32 v3, 3, v0
    v_mul_u32_u24 v3, 1152, v3
    v_and_b32 v12, 7, v0
    v_lshl_add_u32 v3, v12, 4, v3
    v_add_u32 v3, s15, v3
    v_add_u32 v2, 4294963840, v3
    s_add_u32 s13, s13, 2048
    s_waitcnt vmcnt(0)
    v_lshlrev_b32 v56, 16, v16
    v_and_b32 v60, s47, v16
    v_lshlrev_b32 v64, 16, v17
    v_and_b32 v68, s47, v17
    v_lshlrev_b32 v57, 16, v18
    v_and_b32 v61, s47, v18
    v_lshlrev_b32 v65, 16, v19
    v_and_b32 v69, s47, v19
    v_lshlrev_b32 v58, 16, v20
    v_and_b32 v62, s47, v20
    v_lshlrev_b32 v66, 16, v21
    v_and_b32 v70, s47, v21
    v_lshlrev_b32 v59, 16, v22
    v_and_b32 v63, s47, v22
    v_lshlrev_b32 v67, 16, v23
    v_and_b32 v71, s47, v23
    s_mov_b32 s14, 0
L_pl_33:
    ds_read_b64 v[12:13], v7 offset:8
    s_add_u32 s14, s14, 1
    s_waitcnt lgkmcnt(0)
    v_readfirstlane_b32 s8, v12
    v_readfirstlane_b32 s22, v13
    s_cmp_ge_u32 s8, 5
    s_cbranch_scc1 L_pld_34
    s_sleep 1
    s_cmp_lt_u32 s14, 131072
    s_cbranch_scc1 L_pl_33
L_pld_34:
    s_cmp_gt_u32 s22, s12
    s_cbranch_scc1 L_am_35
L_amb_36:
    s_mov_b32 m0, s101
    s_add_u32 s8, s101, 1024
    s_mov_b32 s9, 5760
    buffer_load_dwordx4 v2, s[48:51], 0 offen nt lds
    s_mov_b32 m0, s8
    s_add_u32 s8, s101, 2048
    buffer_load_dwordx4 v3, s[48:51], s9 offen nt lds
    s_mov_b32 m0, s8
    s_mov_b32 s9, 14976
    s_mov_b64 exec, 0xffffff
    s_add_u32 s8, s101, 2432
    buffer_load_dwordx4 v3, s[48:51], s9 offen nt lds
    s_mov_b32 m0, s8
    s_mov_b64 exec, -1
    s_add_u32 s8, s101, 3456
    buffer_load_dwordx4 v3, s[52:55], 0 offen nt lds
    s_mov_b32 m0, s8
    s_mov_b32 s9, 9216
    buffer_load_dwordx4 v3, s[52:55], s9 offen nt lds
    s_mov_b64 exec, 1
    ds_add_u32 v7, v8 offset:8
    s_mov_b64 exec, -1
    s_setprio 3
    s_waitcnt vmcnt(2)
    ds_read_b64 v[26:27], v126 offset:0
    ds_read_b64 v[28:29], v126 offset:128
    ds_read_b64 v[30:31], v126 offset:256
    ds_read_b64 v[32:33], v126 offset:384
    ds_read_b64 v[34:35], v126 offset:512
    ds_read_b64 v[36:37], v126 offset:640
    ds_read_b64 v[38:39], v126 offset:768
    s_waitcnt lgkmcnt(0)
    v_lshlrev_b32 v72, 16, v26
    v_and_b32 v73, s47, v26
    v_lshlrev_b32 v74, 16, v27
    v_and_b32 v75, s47, v27
    v_lshlrev_b32 v76, 16, v28
    v_and_b32 v77, s47, v28
    v_lshlrev_b32 v78, 16, v29
    v_and_b32 v79, s47, v29
    v_lshlrev_b32 v80, 16, v30
    v_and_b32 v81, s47, v30
    v_lshlrev_b32 v82, 16, v31
    v_and_b32 v83, s47, v31
    v_lshlrev_b32 v84, 16, v32
    v_and_b32 v85, s47, v32
    v_lshlrev_b32 v86, 16, v33
    v_and_b32 v87, s47, v33
    v_lshlrev_b32 v88, 16, v34
    v_and_b32 v89, s47, v34
    v_lshlrev_b32 v90, 16, v35
    v_and_b32 v91, s47, v35
    v_lshlrev_b32 v92, 16, v36
    v_and_b32 v93, s47, v36
    v_lshlrev_b32 v94, 16, v37
    v_and_b32 v95, s47, v37
    v_lshlrev_b32 v96, 16, v38
    v_and_b32 v97, s47, v38
    v_lshlrev_b32 v98, 16, v39
    v_and_b32 v99, s47, v39
    v_mul_f32 v100, v72, v68
    v_mul_f32 v101, v73, v69
    v_mul_f32 v102, v74, v70
    v_mul_f32 v103, v75, v71
    v_mul_f32 v104, v76, v68
    v_mul_f32 v105, v77, v69
    v_mul_f32 v106, v78, v70
    v_mul_f32 v107, v79, v71
    v_mul_f32 v108, v80, v68
    v_mul_f32 v109, v81, v69
    v_mul_f32 v110, v82, v70
    v_mul_f32 v111, v83, v71
    v_mul_f32 v112, v84, v68
    v_mul_f32 v113, v85, v69
    v_mul_f32 v114, v86, v70
    v_mul_f32 v115, v87, v71
    v_fma_f32 v100, v76, v64, v100
    v_fma_f32 v101, v77, v65, v101
    v_fma_f32 v102, v78, v66, v102
    v_fma_f32 v103, v79, v67, v103
    v_fma_f32 v104, v80, v64, v104
    v_fma_f32 v105, v81, v65, v105
    v_fma_f32 v106, v82, v66, v106
    v_fma_f32 v107, v83, v67, v107
    v_fma_f32 v108, v84, v64, v108
    v_fma_f32 v109, v85, v65, v109
    v_fma_f32 v110, v86, v66, v110
    v_fma_f32 v111, v87, v67, v111
    v_fma_f32 v112, v88, v64, v112
    v_fma_f32 v113, v89, v65, v113
    v_fma_f32 v114, v90, v66, v114
    v_fma_f32 v115, v91, v67, v115
    v_fma_f32 v100, v80, v60, v100
    v_fma_f32 v101, v81, v61, v101
    v_fma_f32 v102, v82, v62, v102
    v_fma_f32 v103, v83, v63, v103
    v_fma_f32 v104, v84, v60, v104
    v_fma_f32 v105, v85, v61, v105
    v_fma_f32 v106, v86, v62, v106
    v_fma_f32 v107, v87, v63, v107
    v_fma_f32 v108, v88, v60, v108
    v_fma_f32 v109, v89, v61, v109
    v_fma_f32 v110, v90, v62, v110
    v_fma_f32 v111, v91, v63, v111
    v_fma_f32 v112, v92, v60, v112
    v_fma_f32 v113, v93, v61, v113
    v_fma_f32 v114, v94, v62, v114
    v_fma_f32 v115, v95, v63, v115
    s_waitcnt vmcnt(0)
    ds_read_b64 v[40:41], v126 offset:2432
    ds_read_b64 v[42:43], v126 offset:2560
    ds_read_b64 v[44:45], v126 offset:2688
    ds_read_b64 v[46:47], v126 offset:2816
    v_fma_f32 v100, v84, v56, v100
    v_fma_f32 v101, v85, v57, v101
    v_fma_f32 v102, v86, v58, v102
    v_fma_f32 v103, v87, v59, v103
    v_fma_f32 v104, v88, v56, v104
    v_fma_f32 v105, v89, v57, v105
    v_fma_f32 v106, v90, v58, v106
    v_fma_f32 v107, v91, v59, v107
    v_fma_f32 v108, v92, v56, v108
    v_fma_f32 v109, v93, v57, v109
    v_fma_f32 v110, v94, v58, v110
    v_fma_f32 v111, v95, v59, v111
    v_fma_f32 v112, v96, v56, v112
    v_fma_f32 v113, v97, v57, v113
    v_fma_f32 v114, v98, v58, v114
    v_fma_f32 v115, v99, v59, v115
    s_waitcnt lgkmcnt(0)
    s_mov_b64 exec, 1
    ds_add_u32 v7, v8 offset:16
    s_mov_b64 exec, -1
    v_lshlrev_b32 v72, 16, v40
    v_and_b32 v73, s47, v40
    v_lshlrev_b32 v74, 16, v41
    v_and_b32 v75, s47, v41
    v_lshlrev_b32 v76, 16, v42
    v_and_b32 v77, s47, v42
    v_lshlrev_b32 v78, 16, v43
    v_and_b32 v79, s47, v43
    v_lshlrev_b32 v80, 16, v44
    v_and_b32 v81, s47, v44
    v_lshlrev_b32 v82, 16, v45
    v_and_b32 v83, s47, v45
    v_lshlrev_b32 v84, 16, v46
    v_and_b32 v85, s47, v46
    v_lshlrev_b32 v86, 16, v47
    v_and_b32 v87, s47, v47
    v_mul_f32 v100, v100, v72
    v_mul_f32 v101, v101, v73
    v_mul_f32 v102, v102, v74
    v_mul_f32 v103, v103, v75
    v_mul_f32 v104, v104, v76
    v_mul_f32 v105, v105, v77
    v_mul_f32 v106, v106, v78
    v_mul_f32 v107, v107, v79
    v_mul_f32 v108, v108, v80
    v_mul_f32 v109, v109, v81
    v_mul_f32 v110, v110, v82
    v_mul_f32 v111, v111, v83
    v_mul_f32 v112, v112, v84
    v_mul_f32 v113, v113, v85
    v_mul_f32 v114, v114, v86
    v_mul_f32 v115, v115, v87
    v_cvt_pk_bf16_f32 v122, v112, v108
    v_cvt_pk_bf16_f32 v123, v104, v100
    v_cvt_pk_bf16_f32 v120, v113, v109
    v_cvt_pk_bf16_f32 v121, v105, v101
    v_cvt_pk_bf16_f32 v118, v114, v110
    v_cvt_pk_bf16_f32 v119, v106, v102
    v_cvt_pk_bf16_f32 v116, v115, v111
    v_cvt_pk_bf16_f32 v117, v107, v103
    s_nop 1
    v_permlane32_swap_b32 v122, v118
    v_permlane32_swap_b32 v123, v119
    v_permlane32_swap_b32 v120, v116
    v_permlane32_swap_b32 v121, v117
    s_nop 1
    v_permlane16_swap_b32 v122, v120
    v_permlane16_swap_b32 v123, v121
    v_permlane16_swap_b32 v118, v116
    v_permlane16_swap_b32 v119, v117
    s_cmp_eq_u32 s12, 0
    s_cbranch_scc0 L_ms_37
    buffer_store_dwordx4 v[116:119], v9, s[68:71], 0 offen
    buffer_store_dwordx4 v[120:123], v9, s[68:71], 0 offen offset:16
L_md_38:
    v_lshlrev_b32 v56, 16, v24
    v_and_b32 v57, s47, v24
    v_lshlrev_b32 v58, 16, v25
    v_and_b32 v59, s47, v25
    v_mul_f32 v100, v100, v56
    v_mul_f32 v101, v101, v57
    v_mul_f32 v102, v102, v58
    v_mul_f32 v103, v103, v59
    v_mul_f32 v104, v104, v56
    v_mul_f32 v105, v105, v57
    v_mul_f32 v106, v106, v58
    v_mul_f32 v107, v107, v59
    v_mul_f32 v108, v108, v56
    v_mul_f32 v109, v109, v57
    v_mul_f32 v110, v110, v58
    v_mul_f32 v111, v111, v59
    v_mul_f32 v112, v112, v56
    v_mul_f32 v113, v113, v57
    v_mul_f32 v114, v114, v58
    v_mul_f32 v115, v115, v59
    s_waitcnt vmcnt(0)
    s_mov_b64 exec, 15
    s_cmp_eq_u32 s12, 0
    s_cbranch_scc0 L_ma_39
    buffer_store_dword v14, v124, s[80:83], s13 offen
L_mb_40:
    s_mov_b64 exec, -1
    s_mov_b64 exec, 1
    ds_add_u32 v7, v8 offset:20
    s_mov_b64 exec, -1
    s_mov_b32 s14, 0
L_pl_41:
    ds_read_b32 v12, v7 offset:36
    s_add_u32 s14, s14, 1
    s_waitcnt lgkmcnt(0)
    v_readfirstlane_b32 s8, v12
    s_cmp_ge_u32 s8, 4
    s_cbranch_scc1 L_pld_42
    s_sleep 2
    s_cmp_lt_u32 s14, 131072
    s_cbranch_scc1 L_pl_41
L_pld_42:
    buffer_load_dwordx2 v[48:49], v1, s[56:59], 0 offen offset:0 nt
    buffer_load_dwordx2 v[50:51], v1, s[56:59], 0 offen offset:1152 nt
    buffer_load_dwordx2 v[52:53], v1, s[56:59], 0 offen offset:2304 nt
    buffer_load_dwordx2 v[54:55], v1, s[56:59], 0 offen offset:3456 nt
    s_setprio 0
    s_waitcnt vmcnt(0)
    v_lshlrev_b32 v72, 16, v48
    v_and_b32 v73, s47, v48
    v_lshlrev_b32 v74, 16, v49
    v_and_b32 v75, s47, v49
    v_lshlrev_b32 v76, 16, v50
    v_and_b32 v77, s47, v50
    v_lshlrev_b32 v78, 16, v51
    v_and_b32 v79, s47, v51
    v_lshlrev_b32 v80, 16, v52
    v_and_b32 v81, s47, v52
    v_lshlrev_b32 v82, 16, v53
    v_and_b32 v83, s47, v53
    v_lshlrev_b32 v84, 16, v54
    v_and_b32 v85, s47, v54
    v_lshlrev_b32 v86, 16, v55
    v_and_b32 v87, s47, v55
    v_mul_f32 v100, v100, v72
    v_mul_f32 v101, v101, v73
    v_mul_f32 v102, v102, v74
    v_mul_f32 v103, v103, v75
    v_mul_f32 v104, v104, v76
    v_mul_f32 v105, v105, v77
    v_mul_f32 v106, v106, v78
    v_mul_f32 v107, v107, v79
    v_mul_f32 v108, v108, v80
    v_mul_f32 v109, v109, v81
    v_mul_f32 v110, v110, v82
    v_mul_f32 v111, v111, v83
    v_mul_f32 v112, v112, v84
    v_mul_f32 v113, v113, v85
    v_mul_f32 v114, v114, v86
    v_mul_f32 v115, v115, v87
    s_lshl_b32 s8, s23, 9
    s_add_u32 s22, s8, s33
    s_add_u32 s22, s22, 6144
    s_cmp_eq_u32 s12, 0
    s_cbranch_scc0 L_yf_45
    s_mov_b32 s14, 0
L_pl_47:
    ds_read_b32 v12, v7 offset:52
    s_add_u32 s14, s14, 1
    s_waitcnt lgkmcnt(0)
    v_readfirstlane_b32 s8, v12
    s_cmp_ge_u32 s8, 4
    s_cbranch_scc1 L_pld_48
    s_sleep 1
    s_cmp_lt_u32 s14, 131072
    s_cbranch_scc1 L_pl_47
L_pld_48:
    s_mov_b32 s14, 0
L_yl_44:
    buffer_load_dwordx4 v[16:19], v9, s[72:75], 0 offen sc1
    buffer_load_dwordx4 v[20:23], v9, s[72:75], 0 offen offset:16 sc1
    s_add_u32 s14, s14, 1
    s_waitcnt vmcnt(1)
    v_xor_b32 v24, v16, v116
    v_bitop3_b32 v24, v24, v17, v117 bitop3:0xf6
    v_xor_b32 v25, v18, v118
    v_bitop3_b32 v25, v25, v19, v119 bitop3:0xf6
    s_waitcnt vmcnt(0)
    v_xor_b32 v26, v20, v120
    v_bitop3_b32 v26, v26, v21, v121 bitop3:0xf6
    v_xor_b32 v27, v22, v122
    v_bitop3_b32 v27, v27, v23, v123 bitop3:0xf6
    v_min3_u32 v24, v24, v25, v26
    v_min_u32 v24, v24, v27
    v_cmp_eq_u32 vcc, 0, v24
    s_cbranch_vccz L_yg_43
    s_sleep 1
    s_cmp_lt_u32 s14, 6
    s_cbranch_scc1 L_yl_44
L_yf_45:
    s_mov_b32 s14, 0
L_pg_49:
    buffer_load_dwordx2 v[12:13], v15, s[80:83], s22 offen sc1
    s_add_u32 s14, s14, 1
    s_waitcnt vmcnt(0)
    v_xor_b32 v12, s26, v12
    v_bitop3_b32 v12, v12, v13, s26 bitop3:0xf6
    v_cmp_ne_u32 vcc, 0, v12
    s_cbranch_vccz L_pgd_50
    s_sleep 1
    s_and_b32 s8, s14, 63
    s_cbranch_scc1 L_pg_49
    s_branch L_pgc_51
L_pgd_50:
    buffer_load_dwordx4 v[16:19], v9, s[72:75], 0 offen sc1
    buffer_load_dwordx4 v[20:23], v9, s[72:75], 0 offen offset:16 sc1
    s_waitcnt vmcnt(0)
L_yg_43:
    s_nop 1
    v_permlane32_swap_b32 v16, v20
    v_permlane32_swap_b32 v17, v21
    v_permlane32_swap_b32 v18, v22
    v_permlane32_swap_b32 v19, v23
    s_nop 1
    v_permlane16_swap_b32 v16, v18
    v_permlane16_swap_b32 v17, v19
    v_permlane16_swap_b32 v20, v22
    v_permlane16_swap_b32 v21, v23
    v_lshlrev_b32 v24, 16, v16
    v_and_b32 v28, s47, v16
    v_lshlrev_b32 v32, 16, v17
    v_and_b32 v36, s47, v17
    v_lshlrev_b32 v25, 16, v18
    v_and_b32 v29, s47, v18
    v_lshlrev_b32 v33, 16, v19
    v_and_b32 v37, s47, v19
    v_lshlrev_b32 v26, 16, v20
    v_and_b32 v30, s47, v20
    v_lshlrev_b32 v34, 16, v21
    v_and_b32 v38, s47, v21
    v_lshlrev_b32 v27, 16, v22
    v_and_b32 v31, s47, v22
    v_lshlrev_b32 v35, 16, v23
    v_and_b32 v39, s47, v23
    v_pk_fma_f32 v[24:25], v[72:73], v[24:25], v[100:101]
    v_pk_fma_f32 v[26:27], v[74:75], v[26:27], v[102:103]
    v_cvt_pk_bf16_f32 v16, v24, v25
    v_cvt_pk_bf16_f32 v17, v26, v27
    buffer_store_dwordx2 v[16:17], v10, s[76:79], 0 offen offset:0
    v_pk_fma_f32 v[28:29], v[76:77], v[28:29], v[104:105]
    v_pk_fma_f32 v[30:31], v[78:79], v[30:31], v[106:107]
    v_cvt_pk_bf16_f32 v18, v28, v29
    v_cvt_pk_bf16_f32 v19, v30, v31
    buffer_store_dwordx2 v[18:19], v10, s[76:79], 0 offen offset:2304
    v_pk_fma_f32 v[32:33], v[80:81], v[32:33], v[108:109]
    v_pk_fma_f32 v[34:35], v[82:83], v[34:35], v[110:111]
    v_cvt_pk_bf16_f32 v20, v32, v33
    v_cvt_pk_bf16_f32 v21, v34, v35
    buffer_store_dwordx2 v[20:21], v11, s[76:79], 0 offen offset:0
    v_pk_fma_f32 v[36:37], v[84:85], v[36:37], v[112:113]
    v_pk_fma_f32 v[38:39], v[86:87], v[38:39], v[114:115]
    v_cvt_pk_bf16_f32 v22, v36, v37
    v_cvt_pk_bf16_f32 v23, v38, v39
    buffer_store_dwordx2 v[22:23], v11, s[76:79], 0 offen offset:2304
    s_endpgm
L_am_35:
    s_mov_b32 s12, 1
    s_mov_b32 s26, s27
    v_mov_b32 v14, s27
    s_add_u32 s33, s33, 16384
    s_mov_b64 s[68:69], s[44:45]
    s_add_u32 s72, s44, 4718592
    s_addc_u32 s73, s45, 0
    s_branch L_amb_36
L_ms_37:
    buffer_store_dwordx4 v[116:119], v9, s[68:71], 0 offen sc1
    buffer_store_dwordx4 v[120:123], v9, s[68:71], 0 offen offset:16 sc1
    s_branch L_md_38
L_ma_39:
    s_mov_b64 exec, 1
    v_mov_b32 v16, 1
    buffer_atomic_add v16, off, s[60:63], s34 offset:16 sc0 sc1
    s_waitcnt vmcnt(0)
    v_readfirstlane_b32 s8, v16
    s_cmp_eq_u32 s8, 127
    s_cbranch_scc0 L_mb_40
    s_mov_b64 exec, -1
    s_add_u32 s9, s33, 2048
    v_lshlrev_b32 v20, 4, v0
    v_mov_b32 v16, v14
    v_mov_b32 v17, v14
    v_mov_b32 v18, v14
    v_mov_b32 v19, v14
    buffer_store_dwordx4 v[16:19], v20, s[80:83], s9 offen offset:0 sc1
    buffer_store_dwordx4 v[16:19], v20, s[80:83], s9 offen offset:1024 sc1
    buffer_store_dwordx4 v[16:19], v20, s[80:83], s9 offen offset:0
    buffer_store_dwordx4 v[16:19], v20, s[80:83], s9 offen offset:1024
    s_branch L_mb_40
L_pgc_51:
    s_cmp_eq_u32 s12, 0
    s_cbranch_scc1 L_pgr_52
    s_mov_b64 exec, 1
    v_mov_b32 v12, 0
    buffer_atomic_add v12, off, s[60:63], s34 offset:12 sc0 sc1
    s_waitcnt vmcnt(0)
    v_readfirstlane_b32 s8, v12
    s_mov_b64 exec, -1
    s_cmp_ge_u32 s8, 128
    s_cbranch_scc1 L_pgd_50
L_pgr_52:
    s_cmp_lt_u32 s14, 32768
    s_cbranch_scc1 L_pg_49
    s_branch L_pgd_50
L_ex_8:
    s_add_u32 s68, s44, 16777216
    s_addc_u32 s69, s45, 0
    s_add_u32 s72, s44, 17301504
    s_addc_u32 s73, s45, 0
    v_and_b32 v12, 4095, v9
    v_lshrrev_b32 v12, 1, v12
    v_add_u32 v12, s101, v12
    ds_write_b128 v12, v[116:119]
    ds_write_b128 v12, v[120:123] offset:16
    v_lshl_add_u32 v12, v0, 3, s101
    ds_read_b64 v[72:73], v12 offset:0
    ds_read_b64 v[74:75], v12 offset:512
    ds_read_b64 v[76:77], v12 offset:1024
    ds_read_b64 v[78:79], v12 offset:1536
    v_and_b32 v5, 0xfffff000, v9
    v_lshl_add_u32 v5, v0, 4, v5
    v_mov_b32 v2, s25
    s_waitcnt lgkmcnt(3)
    v_lshl_or_b32 v40, v72, 16, v2
    v_and_or_b32 v41, v72, s47, v2
    v_lshl_or_b32 v42, v73, 16, v2
    v_and_or_b32 v43, v73, s47, v2
    buffer_store_dwordx4 v[40:43], v5, s[68:71], 0 offen offset:0 sc1
    s_waitcnt lgkmcnt(2)
    v_lshl_or_b32 v44, v74, 16, v2
    v_and_or_b32 v45, v74, s47, v2
    v_lshl_or_b32 v46, v75, 16, v2
    v_and_or_b32 v47, v75, s47, v2
    buffer_store_dwordx4 v[44:47], v5, s[68:71], 0 offen offset:1024 sc1
    s_waitcnt lgkmcnt(1)
    v_lshl_or_b32 v48, v76, 16, v2
    v_and_or_b32 v49, v76, s47, v2
    v_lshl_or_b32 v50, v77, 16, v2
    v_and_or_b32 v51, v77, s47, v2
    buffer_store_dwordx4 v[48:51], v5, s[68:71], 0 offen offset:2048 sc1
    s_waitcnt lgkmcnt(0)
    v_lshl_or_b32 v52, v78, 16, v2
    v_and_or_b32 v53, v78, s47, v2
    v_lshl_or_b32 v54, v79, 16, v2
    v_and_or_b32 v55, v79, s47, v2
    buffer_store_dwordx4 v[52:55], v5, s[68:71], 0 offen offset:3072 sc1
    v_lshlrev_b32 v56, 16, v24
    v_and_b32 v57, s47, v24
    v_lshlrev_b32 v58, 16, v25
    v_and_b32 v59, s47, v25
    v_pk_mul_f32 v[100:101], v[100:101], v[56:57]
    v_pk_mul_f32 v[102:103], v[102:103], v[58:59]
    v_pk_mul_f32 v[104:105], v[104:105], v[56:57]
    v_pk_mul_f32 v[106:107], v[106:107], v[58:59]
    v_pk_mul_f32 v[108:109], v[108:109], v[56:57]
    v_pk_mul_f32 v[110:111], v[110:111], v[58:59]
    v_pk_mul_f32 v[112:113], v[112:113], v[56:57]
    v_pk_mul_f32 v[114:115], v[114:115], v[58:59]
    s_lshr_b32 s8, s16, 5
    s_lshl_b32 s9, s8, 13
    s_lshl_b32 s10, s6, 21
    s_add_u32 s9, s9, s10
    s_bfe_u32 s10, s16, 65540
    s_lshl_b32 s10, s10, 6
    s_add_u32 s9, s9, s10
    v_lshrrev_b32 v9, 2, v0
    v_add_u32 v12, s8, v9
    v_and_b32 v12, 7, v12
    v_and_b32 v9, 8, v9
    v_or_b32 v9, v9, v12
    v_lshl_add_u32 v9, v9, 7, s9
    v_and_b32 v12, 3, v0
    v_lshl_add_u32 v9, v12, 4, v9
    v_lshlrev_b32 v2, 3, v0
    v_add_u32 v2, 143392, v2
    v_and_b32 v3, 15, v0
    v_lshlrev_b32 v3, 7, v3
    v_lshrrev_b32 v12, 4, v0
    v_lshl_add_u32 v3, v12, 3, v3
    v_add_u32 v3, 143392, v3
    s_mov_b32 s14, 0
L_pl_53:
    ds_read_b32 v12, v7 offset:36
    s_add_u32 s14, s14, 1
    s_waitcnt lgkmcnt(0)
    v_readfirstlane_b32 s8, v12
    s_cmp_ge_u32 s8, 4
    s_cbranch_scc1 L_pld_54
    s_sleep 3
    s_cmp_lt_u32 s14, 131072
    s_cbranch_scc1 L_pl_53
L_pld_54:
    buffer_load_dwordx2 v[48:49], v1, s[56:59], 0 offen offset:0 nt
    buffer_load_dwordx2 v[50:51], v1, s[56:59], 0 offen offset:1152 nt
    buffer_load_dwordx2 v[52:53], v1, s[56:59], 0 offen offset:2304 nt
    buffer_load_dwordx2 v[54:55], v1, s[56:59], 0 offen offset:3456 nt
    s_mov_b32 s14, 0
L_pl_55:
    ds_read_b32 v12, v7 offset:56
    s_add_u32 s14, s14, 1
    s_waitcnt lgkmcnt(0)
    v_readfirstlane_b32 s8, v12
    s_cmp_ge_u32 s8, 4
    s_cbranch_scc1 L_pld_56
    s_sleep 2
    s_cmp_lt_u32 s14, 131072
    s_cbranch_scc1 L_pl_55
L_pld_56:
    s_mov_b32 s14, 0
    buffer_load_dwordx4 v[24:27], v9, s[72:75], 0 offen offset:0 sc1
    buffer_load_dwordx4 v[28:31], v9, s[72:75], 0 offen offset:2048 sc1
    s_mov_b32 s9, 4096
    buffer_load_dwordx4 v[32:35], v9, s[72:75], s9 offen offset:0 sc1
    s_mov_b32 s9, 4096
    buffer_load_dwordx4 v[36:39], v9, s[72:75], s9 offen offset:2048 sc1
    s_waitcnt vmcnt(0)
L_tl_57:
    v_xor_b32 v12, s25, v24
    v_bitop3_b32 v12, v12, v25, s25 bitop3:0xf6
    v_bitop3_b32 v12, v12, v26, s25 bitop3:0xf6
    v_bitop3_b32 v12, v12, v27, s25 bitop3:0xf6
    v_bitop3_b32 v12, v12, v28, s25 bitop3:0xf6
    v_bitop3_b32 v12, v12, v29, s25 bitop3:0xf6
    v_bitop3_b32 v12, v12, v30, s25 bitop3:0xf6
    v_bitop3_b32 v12, v12, v31, s25 bitop3:0xf6
    v_bitop3_b32 v12, v12, v32, s25 bitop3:0xf6
    v_bitop3_b32 v12, v12, v33, s25 bitop3:0xf6
    v_bitop3_b32 v12, v12, v34, s25 bitop3:0xf6
    v_bitop3_b32 v12, v12, v35, s25 bitop3:0xf6
    v_bitop3_b32 v12, v12, v36, s25 bitop3:0xf6
    v_bitop3_b32 v12, v12, v37, s25 bitop3:0xf6
    v_bitop3_b32 v12, v12, v38, s25 bitop3:0xf6
    v_bitop3_b32 v12, v12, v39, s25 bitop3:0xf6
    v_and_b32 v12, 0xffff, v12
    v_cmp_ne_u32 vcc, 0, v12
    s_cbranch_vccnz L_tlc_59
L_tld_58:
    s_mov_b32 s8, 0x07060302
    v_perm_b32 v16, v25, v24, s8
    v_perm_b32 v17, v27, v26, s8
    ds_write_b64 v2, v[16:17] offset:0
    v_perm_b32 v18, v29, v28, s8
    v_perm_b32 v19, v31, v30, s8
    ds_write_b64 v2, v[18:19] offset:512
    v_perm_b32 v20, v33, v32, s8
    v_perm_b32 v21, v35, v34, s8
    ds_write_b64 v2, v[20:21] offset:1024
    v_perm_b32 v22, v37, v36, s8
    v_perm_b32 v23, v39, v38, s8
    ds_write_b64 v2, v[22:23] offset:1536
    ds_read_b64 v[16:17], v3 offset:0
    ds_read_b64 v[18:19], v3 offset:32
    ds_read_b64 v[20:21], v3 offset:64
    ds_read_b64 v[22:23], v3 offset:96
    s_setprio 0
    s_waitcnt vmcnt(0)
    v_lshlrev_b32 v72, 16, v48
    v_and_b32 v73, s47, v48
    v_lshlrev_b32 v74, 16, v49
    v_and_b32 v75, s47, v49
    v_lshlrev_b32 v76, 16, v50
    v_and_b32 v77, s47, v50
    v_lshlrev_b32 v78, 16, v51
    v_and_b32 v79, s47, v51
    v_lshlrev_b32 v80, 16, v52
    v_and_b32 v81, s47, v52
    v_lshlrev_b32 v82, 16, v53
    v_and_b32 v83, s47, v53
    v_lshlrev_b32 v84, 16, v54
    v_and_b32 v85, s47, v54
    v_lshlrev_b32 v86, 16, v55
    v_and_b32 v87, s47, v55
    v_mul_f32 v100, v100, v72
    v_mul_f32 v101, v101, v73
    v_mul_f32 v102, v102, v74
    v_mul_f32 v103, v103, v75
    v_mul_f32 v104, v104, v76
    v_mul_f32 v105, v105, v77
    v_mul_f32 v106, v106, v78
    v_mul_f32 v107, v107, v79
    v_mul_f32 v108, v108, v80
    v_mul_f32 v109, v109, v81
    v_mul_f32 v110, v110, v82
    v_mul_f32 v111, v111, v83
    v_mul_f32 v112, v112, v84
    v_mul_f32 v113, v113, v85
    v_mul_f32 v114, v114, v86
    v_mul_f32 v115, v115, v87
    s_waitcnt lgkmcnt(0)
    s_branch L_ez_122
L_tlc_59:
    s_add_u32 s14, s14, 1
    s_cmp_lt_u32 s14, 32768
    s_cbranch_scc0 L_tld_58
    s_and_b32 s8, s14, 63
    s_cbranch_scc1 L_tlr_60
    buffer_inv sc1
L_tlr_60:
    s_sleep 2
    buffer_load_dwordx4 v[24:27], v9, s[72:75], 0 offen offset:0 sc1
    buffer_load_dwordx4 v[28:31], v9, s[72:75], 0 offen offset:2048 sc1
    s_mov_b32 s9, 4096
    buffer_load_dwordx4 v[32:35], v9, s[72:75], s9 offen offset:0 sc1
    s_mov_b32 s9, 4096
    buffer_load_dwordx4 v[36:39], v9, s[72:75], s9 offen offset:2048 sc1
    s_waitcnt vmcnt(0)
    s_branch L_tl_57
L_Cm:
    s_setprio 2
    s_lshl_b32 s33, s6, 21
    s_add_u32 s33, s33, 17825792
    s_add_u32 s80, s44, s33
    s_addc_u32 s81, s45, 0
    s_mov_b32 s82, 163840
    s_mov_b32 s83, 0x00020000
    s_add_u32 s33, s7, 1
    s_lshl_b32 s33, s33, 15
    s_mov_b64 s[60:61], s[42:43]
    s_mov_b32 s62, 256
    s_mov_b32 s63, 0x00020000
    s_mul_i32 s34, s7, 20
    s_lshl_b32 s8, s6, 7
    s_add_u32 s34, s34, s8
    s_add_u32 s34, s34, 8
    s_mov_b64 s[68:69], s[40:41]
    s_mov_b32 s70, 4718592
    s_mov_b32 s71, 0x00020000
    s_mov_b64 s[72:73], s[40:41]
    s_mov_b32 s74, 4718592
    s_mov_b32 s75, 0x00020000
    s_mov_b32 s12, 0
    s_mov_b32 s35, s46
    s_mov_b32 s18, s47
    s_mul_i32 s22, s35, 18560
    s_mul_i32 s23, s35, 8480
    s_add_u32 s23, s23, 92800
    v_mov_b32 v56, 0
    v_mov_b32 v57, 0
    v_mov_b32 v58, 0
    v_mov_b32 v59, 0
    v_lshl_add_u32 v48, v0, 4, s22
    ds_write_b128 v48, v[56:59] offset:0
    ds_write_b128 v48, v[56:59] offset:4640
    ds_write_b128 v48, v[56:59] offset:9280
    ds_write_b128 v48, v[56:59] offset:13920
    v_lshl_add_u32 v49, v0, 4, s23
    v_add_u32 v50, 6264, v49
    v_lshlrev_b32 v62, 3, v0
    v_cmp_lt_u32 vcc, 14, v0
    v_add_u32 v62, s23, v62
    v_add_u32 v63, 4096, v62
    v_cndmask_b32 v62, v62, v63, vcc
    v_and_b32 v12, 3, v0
    v_mul_u32_u24 v1, 4640, v12
    v_bfe_u32 v2, v0, 2, 2
    v_lshl_add_u32 v1, v2, 7, v1
    v_lshrrev_b32 v2, 4, v0
    v_lshl_add_u32 v1, v2, 4, v1
    s_lshl_b32 s8, s35, 7
    s_add_u32 s9, s8, 74240
    v_add_u32 v3, s9, v1
    v_add_u32 v1, s22, v1
    v_lshlrev_b32 v2, 4, v2
    v_and_b32 v4, 15, v0
    v_lshlrev_b32 v4, 3, v4
    v_sub_u32 v2, v2, v4
    v_add_u32 v2, 120, v2
    v_and_b32 v4, 1, v0
    v_xor_b32 v4, 1, v4
    v_mul_u32_u24 v4, 4216, v4
    v_add_u32 v2, v2, v4
    s_add_u32 s9, s8, 126720
    v_add_u32 v4, s9, v2
    v_add_u32 v2, s23, v2
    s_and_b32 s32, s5, 1
    s_lshl_b32 s10, s35, 5
    s_add_u32 s18, s18, s10
    v_lshrrev_b32 v5, 2, v0
    v_add_u32 v60, s15, v5
    v_and_b32 v60, 15, v60
    v_lshl_add_u32 v5, v5, 4, v60
    v_mul_u32_u24 v5, 2304, v5
    v_add_u32 v5, s18, v5
    v_lshl_add_u32 v5, v12, 3, v5
    v_lshrrev_b32 v6, 2, v0
    v_lshlrev_b32 v6, 7, v6
    v_lshl_add_u32 v6, v12, 3, v6
    s_lshl_b32 s10, s35, 5
    s_add_u32 s10, s10, 135200
    v_add_u32 v6, s10, v6
    s_lshl_b32 s8, s35, 10
    s_add_u32 s8, s8, 145440
    v_lshl_add_u32 v7, v0, 4, s8
    v_mov_b32 v9, 163360
    v_mov_b32 v10, 1
    v_lshlrev_b32 v15, 3, v0
    v_lshlrev_b32 v11, 9, v0
    s_lshl_b32 s13, s5, 2
    s_add_u32 s13, s13, s35
    s_lshl_b32 s13, s13, 2
    s_add_u32 s13, s13, s33
    s_add_u32 s13, s13, 6144
    s_lshl_b32 s8, s35, 4
    s_sub_u32 s8, 63, s8
    v_lshrrev_b32 v52, 3, v0
    v_sub_u32 v60, s8, v52
    v_add_u32 v61, -8, v60
    v_add_u32 v12, s15, v60
    v_and_b32 v12, 15, v12
    v_lshl_add_u32 v60, v60, 4, v12
    v_mul_u32_u24 v60, 2304, v60
    v_add_u32 v60, s47, v60
    v_add_u32 v12, s15, v61
    v_and_b32 v12, 15, v12
    v_lshl_add_u32 v61, v61, 4, v12
    v_mul_u32_u24 v61, 2304, v61
    v_add_u32 v61, s47, v61
    v_and_b32 v12, 7, v0
    v_lshl_add_u32 v60, v12, 4, v60
    v_lshl_add_u32 v61, v12, 4, v61
    s_lshl_b32 s8, s35, 9
    s_add_u32 s8, s8, 94848
    v_lshl_add_u32 v52, v52, 5, s8
    v_lshrrev_b32 v12, 1, v12
    v_mul_u32_u24 v12, 8480, v12
    v_add_u32 v52, v52, v12
    v_and_b32 v12, 1, v0
    v_lshl_add_u32 v52, v12, 4, v52
    v_add_u32 v53, 4216, v52
    s_lshl_b32 s24, s35, 9
    s_add_u32 s24, s24, s33
    s_add_u32 s24, s24, 0
    s_waitcnt vmcnt(7)
    v_mov_b32_dpp v64, v68 wave_shr:1 row_mask:0xf bank_mask:0xf bound_ctrl:0
    v_mov_b32_dpp v65, v69 wave_shr:1 row_mask:0xf bank_mask:0xf bound_ctrl:0
    ds_write_b128 v48, v[66:69] offset:14304
    v_alignbit_b32 v80, v65, v64, 16
    v_alignbit_b32 v81, v66, v65, 16
    v_alignbit_b32 v82, v67, v66, 16
    v_alignbit_b32 v83, v68, v67, 16
    ds_write_b128 v48, v[80:83] offset:384
    v_alignbit_b32 v84, v66, v65, 16
    v_alignbit_b32 v85, v67, v66, 16
    v_alignbit_b32 v86, v68, v67, 16
    v_alignbit_b32 v87, v69, v68, 16
    ds_write_b128 v48, v[84:87] offset:9664
    v_pk_mov_b32 v[88:89], v[64:65], v[66:67] op_sel:[1,0]
    v_pk_mov_b32 v[90:91], v[66:67], v[68:69] op_sel:[1,0]
    ds_write_b128 v48, v[88:91] offset:5024
    s_waitcnt vmcnt(5)
    v_mov_b32_dpp v72, v76 wave_shr:1 row_mask:0xf bank_mask:0xf
    v_mov_b32_dpp v73, v77 wave_shr:1 row_mask:0xf bank_mask:0xf
    ds_write_b128 v48, v[74:77] offset:15328
    v_alignbit_b32 v16, v73, v72, 16
    v_alignbit_b32 v17, v74, v73, 16
    v_alignbit_b32 v18, v75, v74, 16
    v_alignbit_b32 v19, v76, v75, 16
    ds_write_b128 v48, v[16:19] offset:1408
    v_alignbit_b32 v20, v74, v73, 16
    v_alignbit_b32 v21, v75, v74, 16
    v_alignbit_b32 v22, v76, v75, 16
    v_alignbit_b32 v23, v77, v76, 16
    ds_write_b128 v48, v[20:23] offset:10688
    v_pk_mov_b32 v[24:25], v[72:73], v[74:75] op_sel:[1,0]
    v_pk_mov_b32 v[26:27], v[74:75], v[76:77] op_sel:[1,0]
    ds_write_b128 v48, v[24:27] offset:6048
    s_waitcnt vmcnt(3)
    v_mov_b32_dpp v112, v116 wave_shr:1 row_mask:0xf bank_mask:0xf
    v_mov_b32_dpp v113, v117 wave_shr:1 row_mask:0xf bank_mask:0xf
    ds_write_b128 v48, v[114:117] offset:16352
    v_alignbit_b32 v80, v113, v112, 16
    v_alignbit_b32 v81, v114, v113, 16
    v_alignbit_b32 v82, v115, v114, 16
    v_alignbit_b32 v83, v116, v115, 16
    ds_write_b128 v48, v[80:83] offset:2432
    v_alignbit_b32 v84, v114, v113, 16
    v_alignbit_b32 v85, v115, v114, 16
    v_alignbit_b32 v86, v116, v115, 16
    v_alignbit_b32 v87, v117, v116, 16
    ds_write_b128 v48, v[84:87] offset:11712
    v_pk_mov_b32 v[88:89], v[112:113], v[114:115] op_sel:[1,0]
    v_pk_mov_b32 v[90:91], v[114:115], v[116:117] op_sel:[1,0]
    ds_write_b128 v48, v[88:91] offset:7072
    s_waitcnt vmcnt(1)
    v_mov_b32_dpp v120, v124 wave_shr:1 row_mask:0xf bank_mask:0xf
    v_mov_b32_dpp v121, v125 wave_shr:1 row_mask:0xf bank_mask:0xf
    ds_write_b128 v48, v[122:125] offset:17376
    v_alignbit_b32 v16, v121, v120, 16
    v_alignbit_b32 v17, v122, v121, 16
    v_alignbit_b32 v18, v123, v122, 16
    v_alignbit_b32 v19, v124, v123, 16
    ds_write_b128 v48, v[16:19] offset:3456
    v_alignbit_b32 v20, v122, v121, 16
    v_alignbit_b32 v21, v123, v122, 16
    v_alignbit_b32 v22, v124, v123, 16
    v_alignbit_b32 v23, v125, v124, 16
    ds_write_b128 v48, v[20:23] offset:12736
    v_pk_mov_b32 v[24:25], v[120:121], v[122:123] op_sel:[1,0]
    v_pk_mov_b32 v[26:27], v[122:123], v[124:125] op_sel:[1,0]
    ds_write_b128 v48, v[24:27] offset:8096
    s_getreg_b32 s26, hwreg(HW_REG_XCC_ID, 0, 4)
    s_mov_b32 s14, 0
L_gn_61:
    ds_read_b64 v[12:13], v9 offset:0
    s_add_u32 s14, s14, 1
    s_waitcnt lgkmcnt(0)
    v_readfirstlane_b32 s25, v13
    v_readfirstlane_b32 s27, v12
    s_cmp_ge_u32 s25, 1
    s_cbranch_scc1 L_gnd_62
    s_sleep 1
    s_cmp_lt_u32 s14, 131072
    s_cbranch_scc1 L_gn_61
L_gnd_62:
    s_add_u32 s26, s26, s27
    s_add_u32 s26, s26, 1
    v_mov_b32 v14, s26
    s_and_b32 s25, s25, 0xffff
    s_mov_b32 s14, 0
L_pg_63:
    buffer_load_dwordx2 v[80:81], v15, s[80:83], s24 offen sc1
    s_add_u32 s14, s14, 1
    s_waitcnt vmcnt(0)
    v_xor_b32 v80, s26, v80
    v_bitop3_b32 v80, v80, v81, s26 bitop3:0xf6
    v_cmp_ne_u32 vcc, 0, v80
    s_cbranch_vccz L_pgd_64
    s_and_b32 s8, s14, 63
    s_cbranch_scc1 L_pg_63
    s_branch L_pgc_65
L_pgd_64:
    buffer_load_dwordx4 v[64:67], v60, s[68:71], 0 offen sc1
    buffer_load_dwordx4 v[68:71], v61, s[68:71], 0 offen sc1
    s_mov_b64 exec, 1
    ds_add_u32 v9, v10 offset:8
    s_mov_b64 exec, -1
    s_mov_b32 exec_hi, 0
    ds_write_b64 v62, v[56:57] offset:4096
    s_mov_b32 exec_hi, -1
    s_cmp_lg_u32 s12, 0
    s_cselect_b64 vcc, -1, 0
    s_cmp_eq_u32 s32, 0
    s_cbranch_scc0 L_C1
    ds_read_b128 v[72:75], v1 offset:0
    ds_read_b128 v[84:87], v1 offset:512
    s_waitcnt vmcnt(1)
    ds_write_b128 v52, v[64:67] offset:0
    ds_write2_b64 v53, v[64:65], v[66:67] offset0:0 offset1:1
    s_waitcnt vmcnt(0)
    ds_write_b128 v52, v[68:71] offset:256
    ds_write2_b64 v53, v[68:69], v[70:71] offset0:32 offset1:33
    s_waitcnt lgkmcnt(0)
    s_mov_b64 exec, 1
    ds_add_u32 v9, v10 offset:40
    s_mov_b64 exec, -1
    s_mov_b32 s14, 0
L_pl_67:
    ds_read_b32 v12, v9 offset:40
    s_add_u32 s14, s14, 1
    s_waitcnt lgkmcnt(0)
    v_readfirstlane_b32 s8, v12
    s_cmp_ge_u32 s8, 4
    s_cbranch_scc1 L_pld_68
    s_cmp_lt_u32 s14, 131072
    s_cbranch_scc1 L_pl_67
L_pld_68:
    ds_read_b128 v[76:79], v2 offset:3584
    ds_read_b128 v[80:83], v2 offset:3072
    ds_read_b128 v[88:91], v2 offset:2560
    s_waitcnt lgkmcnt(2)
    v_mfma_f32_16x16x32_bf16 v[16:19], v[72:75], v[76:79], 0
    ds_read_b128 v[92:95], v1 offset:1024
    s_waitcnt lgkmcnt(2)
    v_mfma_f32_16x16x32_bf16 v[20:23], v[72:75], v[80:83], 0
    ds_read_b128 v[96:99], v2 offset:2048
    v_mfma_f32_16x16x32_bf16 v[20:23], v[84:87], v[76:79], v[20:23]
    ds_read_b128 v[100:103], v1 offset:1536
    v_mfma_f32_16x16x32_bf16 v[24:27], v[84:87], v[80:83], 0
    ds_read_b128 v[104:107], v1 offset:64
    s_waitcnt lgkmcnt(4)
    v_mfma_f32_16x16x32_bf16 v[24:27], v[72:75], v[88:91], v[24:27]
    ds_read_b128 v[108:111], v2 offset:3648
    s_waitcnt lgkmcnt(4)
    v_mfma_f32_16x16x32_bf16 v[24:27], v[92:95], v[76:79], v[24:27]
    ds_read_b128 v[112:115], v2 offset:3136
    v_mfma_f32_16x16x32_bf16 v[28:31], v[84:87], v[88:91], 0
    ds_read_b128 v[116:119], v1 offset:576
    v_mfma_f32_16x16x32_bf16 v[28:31], v[92:95], v[80:83], v[28:31]
    ds_read_b128 v[120:123], v2 offset:2624
    v_mfma_f32_16x16x32_bf16 v[32:35], v[92:95], v[88:91], 0
    ds_read_b128 v[124:127], v1 offset:1088
    s_waitcnt lgkmcnt(7)
    v_mfma_f32_16x16x32_bf16 v[28:31], v[72:75], v[96:99], v[28:31]
    s_waitcnt lgkmcnt(6)
    v_mfma_f32_16x16x32_bf16 v[28:31], v[100:103], v[76:79], v[28:31]
    v_mfma_f32_16x16x32_bf16 v[32:35], v[84:87], v[96:99], v[32:35]
    v_mfma_f32_16x16x32_bf16 v[32:35], v[100:103], v[80:83], v[32:35]
    ds_read_b128 v[72:75], v2 offset:2112
    v_mfma_f32_16x16x32_bf16 v[36:39], v[92:95], v[96:99], 0
    ds_read_b128 v[76:79], v1 offset:1600
    v_mfma_f32_16x16x32_bf16 v[36:39], v[100:103], v[88:91], v[36:39]
    v_mfma_f32_16x16x32_bf16 v[40:43], v[100:103], v[96:99], 0
    s_waitcnt lgkmcnt(3)
    v_mfma_f32_16x16x32_bf16 v[16:19], v[104:107], v[108:111], v[16:19]
    v_mfma_f32_16x16x32_bf16 v[20:23], v[104:107], v[112:115], v[20:23]
    v_mfma_f32_16x16x32_bf16 v[20:23], v[116:119], v[108:111], v[20:23]
    v_mfma_f32_16x16x32_bf16 v[24:27], v[116:119], v[112:115], v[24:27]
    ds_read_b128 v[84:87], v1 offset:128
    v_mfma_f32_16x16x32_bf16 v[24:27], v[104:107], v[120:123], v[24:27]
    ds_read_b128 v[80:83], v2 offset:3712
    s_waitcnt lgkmcnt(3)
    v_mfma_f32_16x16x32_bf16 v[24:27], v[124:127], v[108:111], v[24:27]
    ds_read_b128 v[92:95], v2 offset:3200
    v_mfma_f32_16x16x32_bf16 v[28:31], v[116:119], v[120:123], v[28:31]
    ds_read_b128 v[88:91], v1 offset:640
    v_mfma_f32_16x16x32_bf16 v[28:31], v[124:127], v[112:115], v[28:31]
    ds_read_b128 v[96:99], v2 offset:2688
    v_mfma_f32_16x16x32_bf16 v[32:35], v[124:127], v[120:123], v[32:35]
    ds_read_b128 v[100:103], v1 offset:1152
    v_mfma_f32_16x16x32_bf16 v[28:31], v[104:107], v[72:75], v[28:31]
    s_waitcnt lgkmcnt(6)
    v_mfma_f32_16x16x32_bf16 v[28:31], v[76:79], v[108:111], v[28:31]
    v_mfma_f32_16x16x32_bf16 v[32:35], v[116:119], v[72:75], v[32:35]
    v_mfma_f32_16x16x32_bf16 v[32:35], v[76:79], v[112:115], v[32:35]
    ds_read_b128 v[104:107], v2 offset:2176
    v_mfma_f32_16x16x32_bf16 v[36:39], v[124:127], v[72:75], v[36:39]
    ds_read_b128 v[108:111], v1 offset:1664
    v_mfma_f32_16x16x32_bf16 v[36:39], v[76:79], v[120:123], v[36:39]
    v_mfma_f32_16x16x32_bf16 v[40:43], v[76:79], v[72:75], v[40:43]
    s_waitcnt lgkmcnt(3)
    v_mfma_f32_16x16x32_bf16 v[16:19], v[84:87], v[80:83], v[16:19]
    v_mfma_f32_16x16x32_bf16 v[20:23], v[84:87], v[92:95], v[20:23]
    v_mfma_f32_16x16x32_bf16 v[20:23], v[88:91], v[80:83], v[20:23]
    v_mfma_f32_16x16x32_bf16 v[24:27], v[88:91], v[92:95], v[24:27]
    ds_read_b128 v[116:119], v1 offset:192
    v_mfma_f32_16x16x32_bf16 v[24:27], v[84:87], v[96:99], v[24:27]
    ds_read_b128 v[112:115], v2 offset:3776
    s_waitcnt lgkmcnt(3)
    v_mfma_f32_16x16x32_bf16 v[24:27], v[100:103], v[80:83], v[24:27]
    ds_read_b128 v[124:127], v2 offset:3264
    v_mfma_f32_16x16x32_bf16 v[28:31], v[88:91], v[96:99], v[28:31]
    ds_read_b128 v[120:123], v1 offset:704
    v_mfma_f32_16x16x32_bf16 v[28:31], v[100:103], v[92:95], v[28:31]
    ds_read_b128 v[72:75], v2 offset:2752
    v_mfma_f32_16x16x32_bf16 v[32:35], v[100:103], v[96:99], v[32:35]
    ds_read_b128 v[76:79], v1 offset:1216
    v_mfma_f32_16x16x32_bf16 v[28:31], v[84:87], v[104:107], v[28:31]
    s_waitcnt lgkmcnt(6)
    v_mfma_f32_16x16x32_bf16 v[28:31], v[108:111], v[80:83], v[28:31]
    v_mfma_f32_16x16x32_bf16 v[32:35], v[88:91], v[104:107], v[32:35]
    v_mfma_f32_16x16x32_bf16 v[32:35], v[108:111], v[92:95], v[32:35]
    ds_read_b128 v[84:87], v2 offset:2240
    v_mfma_f32_16x16x32_bf16 v[36:39], v[100:103], v[104:107], v[36:39]
    ds_read_b128 v[80:83], v1 offset:1728
    v_mfma_f32_16x16x32_bf16 v[36:39], v[108:111], v[96:99], v[36:39]
    v_mfma_f32_16x16x32_bf16 v[40:43], v[108:111], v[104:107], v[40:43]
    s_waitcnt lgkmcnt(3)
    v_mfma_f32_16x16x32_bf16 v[16:19], v[116:119], v[112:115], v[16:19]
    v_mfma_f32_16x16x32_bf16 v[20:23], v[116:119], v[124:127], v[20:23]
    v_mfma_f32_16x16x32_bf16 v[20:23], v[120:123], v[112:115], v[20:23]
    v_mfma_f32_16x16x32_bf16 v[24:27], v[120:123], v[124:127], v[24:27]
    ds_read_b128 v[88:91], v1 offset:256
    v_mfma_f32_16x16x32_bf16 v[24:27], v[116:119], v[72:75], v[24:27]
    ds_read_b128 v[92:95], v2 offset:3840
    s_waitcnt lgkmcnt(3)
    v_mfma_f32_16x16x32_bf16 v[24:27], v[76:79], v[112:115], v[24:27]
    ds_read_b128 v[100:103], v2 offset:3328
    v_mfma_f32_16x16x32_bf16 v[28:31], v[120:123], v[72:75], v[28:31]
    ds_read_b128 v[96:99], v1 offset:768
    v_mfma_f32_16x16x32_bf16 v[28:31], v[76:79], v[124:127], v[28:31]
    ds_read_b128 v[104:107], v2 offset:2816
    v_mfma_f32_16x16x32_bf16 v[32:35], v[76:79], v[72:75], v[32:35]
    ds_read_b128 v[108:111], v1 offset:1280
    v_mfma_f32_16x16x32_bf16 v[28:31], v[116:119], v[84:87], v[28:31]
    s_waitcnt lgkmcnt(6)
    v_mfma_f32_16x16x32_bf16 v[28:31], v[80:83], v[112:115], v[28:31]
    v_mfma_f32_16x16x32_bf16 v[32:35], v[120:123], v[84:87], v[32:35]
    v_mfma_f32_16x16x32_bf16 v[32:35], v[80:83], v[124:127], v[32:35]
    ds_read_b128 v[116:119], v2 offset:2304
    v_mfma_f32_16x16x32_bf16 v[36:39], v[76:79], v[84:87], v[36:39]
    ds_read_b128 v[112:115], v1 offset:1792
    v_mfma_f32_16x16x32_bf16 v[36:39], v[80:83], v[72:75], v[36:39]
    v_mfma_f32_16x16x32_bf16 v[40:43], v[80:83], v[84:87], v[40:43]
    s_waitcnt lgkmcnt(3)
    v_mfma_f32_16x16x32_bf16 v[16:19], v[88:91], v[92:95], v[16:19]
    v_mfma_f32_16x16x32_bf16 v[20:23], v[88:91], v[100:103], v[20:23]
    v_mfma_f32_16x16x32_bf16 v[20:23], v[96:99], v[92:95], v[20:23]
    v_mfma_f32_16x16x32_bf16 v[24:27], v[96:99], v[100:103], v[24:27]
    ds_read_b128 v[120:123], v1 offset:320
    v_mfma_f32_16x16x32_bf16 v[24:27], v[88:91], v[104:107], v[24:27]
    ds_read_b128 v[124:127], v2 offset:3904
    s_waitcnt lgkmcnt(3)
    v_mfma_f32_16x16x32_bf16 v[24:27], v[108:111], v[92:95], v[24:27]
    ds_read_b128 v[76:79], v2 offset:3392
    v_mfma_f32_16x16x32_bf16 v[28:31], v[96:99], v[104:107], v[28:31]
    ds_read_b128 v[72:75], v1 offset:832
    v_mfma_f32_16x16x32_bf16 v[28:31], v[108:111], v[100:103], v[28:31]
    ds_read_b128 v[80:83], v2 offset:2880
    v_mfma_f32_16x16x32_bf16 v[32:35], v[108:111], v[104:107], v[32:35]
    ds_read_b128 v[84:87], v1 offset:1344
    v_mfma_f32_16x16x32_bf16 v[28:31], v[88:91], v[116:119], v[28:31]
    s_waitcnt lgkmcnt(6)
    v_mfma_f32_16x16x32_bf16 v[28:31], v[112:115], v[92:95], v[28:31]
    v_mfma_f32_16x16x32_bf16 v[32:35], v[96:99], v[116:119], v[32:35]
    v_mfma_f32_16x16x32_bf16 v[32:35], v[112:115], v[100:103], v[32:35]
    ds_read_b128 v[88:91], v2 offset:2368
    v_mfma_f32_16x16x32_bf16 v[36:39], v[108:111], v[116:119], v[36:39]
    ds_read_b128 v[92:95], v1 offset:1856
    v_mfma_f32_16x16x32_bf16 v[36:39], v[112:115], v[104:107], v[36:39]
    v_mfma_f32_16x16x32_bf16 v[40:43], v[112:115], v[116:119], v[40:43]
    s_waitcnt lgkmcnt(3)
    v_mfma_f32_16x16x32_bf16 v[16:19], v[120:123], v[124:127], v[16:19]
    v_mfma_f32_16x16x32_bf16 v[20:23], v[120:123], v[76:79], v[20:23]
    v_mfma_f32_16x16x32_bf16 v[20:23], v[72:75], v[124:127], v[20:23]
    v_mfma_f32_16x16x32_bf16 v[24:27], v[72:75], v[76:79], v[24:27]
    v_mfma_f32_16x16x32_bf16 v[24:27], v[120:123], v[80:83], v[24:27]
    ds_read_b32 v12, v9 offset:32
    s_waitcnt lgkmcnt(2)
    v_mfma_f32_16x16x32_bf16 v[24:27], v[84:87], v[124:127], v[24:27]
    v_mfma_f32_16x16x32_bf16 v[28:31], v[72:75], v[80:83], v[28:31]
    v_mfma_f32_16x16x32_bf16 v[28:31], v[84:87], v[76:79], v[28:31]
    v_mfma_f32_16x16x32_bf16 v[32:35], v[84:87], v[80:83], v[32:35]
    v_mfma_f32_16x16x32_bf16 v[28:31], v[120:123], v[88:91], v[28:31]
    s_waitcnt lgkmcnt(0)
    v_readfirstlane_b32 s8, v12
    s_cmp_ge_u32 s8, 1
    s_cbranch_scc0 L_ckc_70
L_ck_69:
    ds_read_b128 v[96:99], v3 offset:2048
    v_mfma_f32_16x16x32_bf16 v[28:31], v[92:95], v[124:127], v[28:31]
    ds_read_b128 v[100:103], v4 offset:3584
    v_mfma_f32_16x16x32_bf16 v[32:35], v[72:75], v[88:91], v[32:35]
    ds_read_b128 v[108:111], v4 offset:2048
    v_mfma_f32_16x16x32_bf16 v[32:35], v[92:95], v[76:79], v[32:35]
    ds_read_b128 v[104:107], v3 offset:2560
    v_mfma_f32_16x16x32_bf16 v[36:39], v[84:87], v[88:91], v[36:39]
    ds_read_b128 v[112:115], v4 offset:2560
    v_mfma_f32_16x16x32_bf16 v[36:39], v[92:95], v[80:83], v[36:39]
    ds_read_b128 v[116:119], v3 offset:3072
    ds_read_b128 v[120:123], v4 offset:3072
    v_mfma_f32_16x16x32_bf16 v[40:43], v[92:95], v[88:91], v[40:43]
    ds_read_b128 v[124:127], v3 offset:3584
    s_waitcnt lgkmcnt(6)
    v_mfma_f32_16x16x32_bf16 v[56:59], v[96:99], v[100:103], 0
    ds_read_b128 v[72:75], v3 offset:0
    s_waitcnt lgkmcnt(6)
    v_mfma_f32_16x16x32_bf16 v[60:63], v[96:99], v[108:111], 0
    ds_read_b128 v[76:79], v3 offset:512
    s_waitcnt lgkmcnt(5)
    v_mfma_f32_16x16x32_bf16 v[60:63], v[104:107], v[112:115], v[60:63]
    ds_read_b128 v[84:87], v3 offset:1024
    s_waitcnt lgkmcnt(4)
    v_mfma_f32_16x16x32_bf16 v[60:63], v[116:119], v[120:123], v[60:63]
    ds_read_b128 v[80:83], v3 offset:1536
    s_waitcnt lgkmcnt(4)
    v_mfma_f32_16x16x32_bf16 v[60:63], v[124:127], v[100:103], v[60:63]
    ds_read_b128 v[88:91], v4 offset:1536
    s_waitcnt lgkmcnt(4)
    v_mfma_f32_16x16x32_bf16 v[64:67], v[72:75], v[100:103], 0
    ds_read_b128 v[92:95], v4 offset:0
    v_mfma_f32_16x16x32_bf16 v[68:71], v[72:75], v[108:111], 0
    ds_read_b128 v[96:99], v4 offset:512
    s_waitcnt lgkmcnt(5)
    v_mfma_f32_16x16x32_bf16 v[68:71], v[76:79], v[112:115], v[68:71]
    ds_read_b128 v[104:107], v4 offset:1024
    v_mfma_f32_16x16x32_bf16 v[56:59], v[76:79], v[108:111], v[56:59]
    ds_read_b128 v[116:119], v3 offset:2112
    s_waitcnt lgkmcnt(6)
    v_mfma_f32_16x16x32_bf16 v[68:71], v[84:87], v[120:123], v[68:71]
    ds_read_b128 v[124:127], v4 offset:3648
    v_mfma_f32_16x16x32_bf16 v[56:59], v[84:87], v[112:115], v[56:59]
    ds_read_b128 v[108:111], v4 offset:2112
    s_waitcnt lgkmcnt(7)
    v_mfma_f32_16x16x32_bf16 v[68:71], v[80:83], v[100:103], v[68:71]
    ds_read_b128 v[112:115], v3 offset:2624
    v_mfma_f32_16x16x32_bf16 v[56:59], v[80:83], v[120:123], v[56:59]
    ds_read_b128 v[100:103], v4 offset:2624
    s_waitcnt lgkmcnt(8)
    v_mfma_f32_16x16x32_bf16 v[56:59], v[72:75], v[88:91], v[56:59]
    ds_read_b128 v[120:123], v3 offset:3136
    s_waitcnt lgkmcnt(8)
    v_mfma_f32_16x16x32_bf16 v[60:63], v[72:75], v[92:95], v[60:63]
    ds_read_b128 v[72:75], v4 offset:3136
    s_waitcnt lgkmcnt(8)
    v_mfma_f32_16x16x32_bf16 v[60:63], v[76:79], v[96:99], v[60:63]
    ds_read_b128 v[92:95], v3 offset:3648
    s_waitcnt lgkmcnt(8)
    v_mfma_f32_16x16x32_bf16 v[60:63], v[84:87], v[104:107], v[60:63]
    ds_read_b128 v[76:79], v3 offset:64
    v_mfma_f32_16x16x32_bf16 v[60:63], v[80:83], v[88:91], v[60:63]
    ds_read_b128 v[96:99], v3 offset:576
    s_waitcnt lgkmcnt(8)
    v_mfma_f32_16x16x32_bf16 v[56:59], v[116:119], v[124:127], v[56:59]
    ds_read_b128 v[84:87], v3 offset:1088
    s_waitcnt lgkmcnt(8)
    v_mfma_f32_16x16x32_bf16 v[60:63], v[116:119], v[108:111], v[60:63]
    ds_read_b128 v[104:107], v3 offset:1600
    s_waitcnt lgkmcnt(7)
    v_mfma_f32_16x16x32_bf16 v[60:63], v[112:115], v[100:103], v[60:63]
    ds_read_b128 v[80:83], v4 offset:1600
    s_waitcnt lgkmcnt(6)
    v_mfma_f32_16x16x32_bf16 v[60:63], v[120:123], v[72:75], v[60:63]
    ds_read_b128 v[88:91], v4 offset:64
    s_waitcnt lgkmcnt(6)
    v_mfma_f32_16x16x32_bf16 v[60:63], v[92:95], v[124:127], v[60:63]
    ds_read_b128 v[116:119], v4 offset:576
    s_waitcnt lgkmcnt(6)
    v_mfma_f32_16x16x32_bf16 v[64:67], v[76:79], v[124:127], v[64:67]
    ds_read_b128 v[112:115], v4 offset:1088
    v_mfma_f32_16x16x32_bf16 v[68:71], v[76:79], v[108:111], v[68:71]
    ds_read_b128 v[120:123], v1 offset:384
    s_waitcnt lgkmcnt(7)
    v_mfma_f32_16x16x32_bf16 v[68:71], v[96:99], v[100:103], v[68:71]
    ds_read_b128 v[92:95], v2 offset:3968
    v_mfma_f32_16x16x32_bf16 v[56:59], v[96:99], v[108:111], v[56:59]
    ds_read_b128 v[108:111], v2 offset:3456
    s_waitcnt lgkmcnt(8)
    v_mfma_f32_16x16x32_bf16 v[68:71], v[84:87], v[72:75], v[68:71]
    v_mfma_f32_16x16x32_bf16 v[56:59], v[84:87], v[100:103], v[56:59]
    ds_read_b128 v[100:103], v1 offset:896
    s_waitcnt lgkmcnt(7)
    v_mfma_f32_16x16x32_bf16 v[68:71], v[104:107], v[124:127], v[68:71]
    ds_read_b128 v[124:127], v2 offset:2944
    v_mfma_f32_16x16x32_bf16 v[56:59], v[104:107], v[72:75], v[56:59]
    ds_read_b128 v[72:75], v1 offset:1408
    v_mfma_f32_16x16x32_bf16 v[56:59], v[76:79], v[80:83], v[56:59]
    s_waitcnt lgkmcnt(6)
    v_mfma_f32_16x16x32_bf16 v[60:63], v[76:79], v[88:91], v[60:63]
    ds_read_b128 v[76:79], v2 offset:2432
    v_mfma_f32_16x16x32_bf16 v[60:63], v[96:99], v[116:119], v[60:63]
    ds_read_b128 v[88:91], v1 offset:1920
    v_mfma_f32_16x16x32_bf16 v[60:63], v[84:87], v[112:115], v[60:63]
    v_mfma_f32_16x16x32_bf16 v[60:63], v[104:107], v[80:83], v[60:63]
    s_waitcnt lgkmcnt(5)
    v_mfma_f32_16x16x32_bf16 v[16:19], v[120:123], v[92:95], v[16:19]
    v_mfma_f32_16x16x32_bf16 v[20:23], v[120:123], v[108:111], v[20:23]
    s_waitcnt lgkmcnt(3)
    v_mfma_f32_16x16x32_bf16 v[20:23], v[100:103], v[92:95], v[20:23]
    ds_read_b32 v12, v9 offset:16
    v_mfma_f32_16x16x32_bf16 v[24:27], v[100:103], v[108:111], v[24:27]
    ds_read_b128 v[96:99], v1 offset:448
    v_mfma_f32_16x16x32_bf16 v[24:27], v[120:123], v[124:127], v[24:27]
    ds_read_b128 v[116:119], v2 offset:4032
    s_waitcnt lgkmcnt(4)
    v_mfma_f32_16x16x32_bf16 v[24:27], v[72:75], v[92:95], v[24:27]
    ds_read_b128 v[84:87], v2 offset:3520
    v_mfma_f32_16x16x32_bf16 v[28:31], v[100:103], v[124:127], v[28:31]
    ds_read_b128 v[112:115], v1 offset:960
    v_mfma_f32_16x16x32_bf16 v[28:31], v[72:75], v[108:111], v[28:31]
    s_waitcnt lgkmcnt(4)
    v_readfirstlane_b32 s8, v12
    s_cmp_ge_u32 s8, 4
    s_cbranch_scc0 L_ckc_72
L_ck_71:
    ds_write_b128 v7, v[64:67] offset:0
    v_mfma_f32_16x16x32_bf16 v[32:35], v[72:75], v[124:127], v[32:35]
    ds_write_b128 v7, v[68:71] offset:4096
    v_mfma_f32_16x16x32_bf16 v[28:31], v[120:123], v[76:79], v[28:31]
    ds_write_b128 v7, v[56:59] offset:8192
    v_mfma_f32_16x16x32_bf16 v[28:31], v[88:91], v[92:95], v[28:31]
    ds_write_b128 v7, v[60:63] offset:12288
    v_mfma_f32_16x16x32_bf16 v[32:35], v[100:103], v[76:79], v[32:35]
    ds_read_b128 v[80:83], v2 offset:3008
    v_mfma_f32_16x16x32_bf16 v[32:35], v[88:91], v[108:111], v[32:35]
    ds_read_b128 v[104:107], v1 offset:1472
    v_mfma_f32_16x16x32_bf16 v[36:39], v[72:75], v[76:79], v[36:39]
    ds_read_b128 v[120:123], v2 offset:2496
    v_mfma_f32_16x16x32_bf16 v[36:39], v[88:91], v[124:127], v[36:39]
    ds_read_b128 v[92:95], v1 offset:1984
    v_mfma_f32_16x16x32_bf16 v[40:43], v[88:91], v[76:79], v[40:43]
    s_waitcnt lgkmcnt(4)
    s_mov_b64 exec, 1
    ds_add_u32 v9, v10 offset:44
    s_mov_b64 exec, -1
    v_mfma_f32_16x16x32_bf16 v[16:19], v[96:99], v[116:119], v[16:19]
    v_mfma_f32_16x16x32_bf16 v[20:23], v[96:99], v[84:87], v[20:23]
    v_mfma_f32_16x16x32_bf16 v[20:23], v[112:115], v[116:119], v[20:23]
    v_mfma_f32_16x16x32_bf16 v[24:27], v[112:115], v[84:87], v[24:27]
    ds_read_b128 v[100:103], v1 offset:2048
    s_waitcnt lgkmcnt(5)
    v_mfma_f32_16x16x32_bf16 v[24:27], v[96:99], v[80:83], v[24:27]
    ds_read_b128 v[108:111], v2 offset:3584
    s_waitcnt lgkmcnt(5)
    v_mfma_f32_16x16x32_bf16 v[24:27], v[104:107], v[116:119], v[24:27]
    ds_read_b128 v[72:75], v1 offset:2560
    v_mfma_f32_16x16x32_bf16 v[28:31], v[112:115], v[80:83], v[28:31]
    ds_read_b128 v[124:127], v2 offset:3072
    v_mfma_f32_16x16x32_bf16 v[28:31], v[104:107], v[84:87], v[28:31]
    ds_read_b128 v[76:79], v1 offset:3072
    s_waitcnt lgkmcnt(5)
    v_mfma_f32_16x16x32_bf16 v[28:31], v[96:99], v[120:123], v[28:31]
    v_cvt_pk_bf16_f32 v48, v16, v17
    ds_read_b128 v[88:91], v2 offset:2560
    v_mfma_f32_16x16x32_bf16 v[28:31], v[92:95], v[116:119], v[28:31]
    v_cvt_pk_bf16_f32 v49, v18, v19
    ds_read_b128 v[56:59], v1 offset:3584
    v_mfma_f32_16x16x32_bf16 v[32:35], v[104:107], v[80:83], v[32:35]
    v_cvt_pk_bf16_f32 v50, v20, v21
    v_mfma_f32_16x16x32_bf16 v[32:35], v[112:115], v[120:123], v[32:35]
    v_cvt_pk_bf16_f32 v51, v22, v23
    v_mfma_f32_16x16x32_bf16 v[32:35], v[92:95], v[84:87], v[32:35]
    ds_read_b128 v[60:63], v2 offset:2048
    v_mfma_f32_16x16x32_bf16 v[36:39], v[104:107], v[120:123], v[36:39]
    v_cvt_pk_bf16_f32 v52, v24, v25
    ds_read_b128 v[64:67], v1 offset:2112
    v_mfma_f32_16x16x32_bf16 v[36:39], v[92:95], v[80:83], v[36:39]
    v_cvt_pk_bf16_f32 v53, v26, v27
    ds_read_b128 v[68:71], v2 offset:3648
    v_mfma_f32_16x16x32_bf16 v[40:43], v[92:95], v[120:123], v[40:43]
    ds_read_b128 v[96:99], v1 offset:2624
    s_waitcnt lgkmcnt(6)
    v_mfma_f32_16x16x32_bf16 v[32:35], v[100:103], v[108:111], v[32:35]
    ds_read_b128 v[116:119], v2 offset:3136
    v_mfma_f32_16x16x32_bf16 v[36:39], v[72:75], v[108:111], v[36:39]
    v_cvt_pk_bf16_f32 v54, v28, v29
    ds_read_b128 v[112:115], v1 offset:3136
    v_mfma_f32_16x16x32_bf16 v[36:39], v[100:103], v[124:127], v[36:39]
    v_cvt_pk_bf16_f32 v55, v30, v31
    ds_read_b128 v[84:87], v2 offset:2624
    v_mfma_f32_16x16x32_bf16 v[40:43], v[76:79], v[108:111], v[40:43]
    s_mov_b32 s9, 0
    s_cbranch_vccnz L_ys_73
    buffer_store_dwordx2 v[48:49], v5, s[72:75], s9 offen
L_yd_74:
    ds_read_b128 v[104:107], v1 offset:3648
    v_mfma_f32_16x16x32_bf16 v[40:43], v[72:75], v[124:127], v[40:43]
    s_waitcnt lgkmcnt(7)
    v_mfma_f32_16x16x32_bf16 v[40:43], v[100:103], v[88:91], v[40:43]
    s_mov_b32 s9, 589824
    s_cbranch_vccnz L_ys_75
    buffer_store_dwordx2 v[50:51], v5, s[72:75], s9 offen
L_yd_76:
    v_mfma_f32_16x16x32_bf16 v[44:47], v[56:59], v[108:111], 0
    ds_read_b128 v[80:83], v2 offset:2112
    v_mfma_f32_16x16x32_bf16 v[44:47], v[76:79], v[124:127], v[44:47]
    s_mov_b32 s9, 1179648
    s_cbranch_vccnz L_ys_77
    buffer_store_dwordx2 v[52:53], v5, s[72:75], s9 offen
L_yd_78:
    ds_read_b128 v[92:95], v1 offset:2176
    v_mfma_f32_16x16x32_bf16 v[44:47], v[72:75], v[88:91], v[44:47]
    ds_read_b128 v[120:123], v2 offset:3712
    v_mfma_f32_16x16x32_bf16 v[44:47], v[100:103], v[60:63], v[44:47]
    s_mov_b32 s9, 1769472
    s_cbranch_vccnz L_ys_79
    buffer_store_dwordx2 v[54:55], v5, s[72:75], s9 offen
L_yd_80:
    ds_read_b128 v[108:111], v1 offset:2688
    s_waitcnt lgkmcnt(6)
    v_mfma_f32_16x16x32_bf16 v[32:35], v[64:67], v[68:71], v[32:35]
    ds_read_b128 v[56:59], v2 offset:3200
    v_mfma_f32_16x16x32_bf16 v[36:39], v[96:99], v[68:71], v[36:39]
    ds_read_b128 v[76:79], v1 offset:3200
    v_mfma_f32_16x16x32_bf16 v[36:39], v[64:67], v[116:119], v[36:39]
    ds_read_b128 v[124:127], v2 offset:2688
    v_mfma_f32_16x16x32_bf16 v[40:43], v[112:115], v[68:71], v[40:43]
    ds_read_b128 v[72:75], v1 offset:3712
    v_mfma_f32_16x16x32_bf16 v[40:43], v[96:99], v[116:119], v[40:43]
    s_waitcnt lgkmcnt(7)
    v_mfma_f32_16x16x32_bf16 v[40:43], v[64:67], v[84:87], v[40:43]
    v_mfma_f32_16x16x32_bf16 v[44:47], v[104:107], v[68:71], v[44:47]
    ds_read_b128 v[88:91], v2 offset:2176
    v_mfma_f32_16x16x32_bf16 v[44:47], v[112:115], v[116:119], v[44:47]
    ds_read_b128 v[100:103], v1 offset:2240
    v_mfma_f32_16x16x32_bf16 v[44:47], v[96:99], v[84:87], v[44:47]
    ds_read_b128 v[60:63], v2 offset:3776
    v_mfma_f32_16x16x32_bf16 v[44:47], v[64:67], v[80:83], v[44:47]
    ds_read_b128 v[104:107], v1 offset:2752
    s_waitcnt lgkmcnt(6)
    v_mfma_f32_16x16x32_bf16 v[32:35], v[92:95], v[120:123], v[32:35]
    ds_read_b128 v[68:71], v2 offset:3264
    v_mfma_f32_16x16x32_bf16 v[36:39], v[108:111], v[120:123], v[36:39]
    ds_read_b128 v[112:115], v1 offset:3264
    v_mfma_f32_16x16x32_bf16 v[36:39], v[92:95], v[56:59], v[36:39]
    ds_read_b128 v[116:119], v2 offset:2752
    v_mfma_f32_16x16x32_bf16 v[40:43], v[76:79], v[120:123], v[40:43]
    ds_read_b128 v[84:87], v1 offset:3776
    v_mfma_f32_16x16x32_bf16 v[40:43], v[108:111], v[56:59], v[40:43]
    s_waitcnt lgkmcnt(7)
    v_mfma_f32_16x16x32_bf16 v[40:43], v[92:95], v[124:127], v[40:43]
    v_mfma_f32_16x16x32_bf16 v[44:47], v[72:75], v[120:123], v[44:47]
    ds_read_b128 v[96:99], v2 offset:2240
    v_mfma_f32_16x16x32_bf16 v[44:47], v[76:79], v[56:59], v[44:47]
    ds_read_b128 v[80:83], v1 offset:2304
    v_mfma_f32_16x16x32_bf16 v[44:47], v[108:111], v[124:127], v[44:47]
    ds_read_b128 v[64:67], v2 offset:3840
    v_mfma_f32_16x16x32_bf16 v[44:47], v[92:95], v[88:91], v[44:47]
    ds_read_b128 v[72:75], v1 offset:2816
    s_waitcnt lgkmcnt(6)
    v_mfma_f32_16x16x32_bf16 v[32:35], v[100:103], v[60:63], v[32:35]
    ds_read_b128 v[120:123], v2 offset:3328
    v_mfma_f32_16x16x32_bf16 v[36:39], v[104:107], v[60:63], v[36:39]
    ds_read_b128 v[76:79], v1 offset:3328
    v_mfma_f32_16x16x32_bf16 v[36:39], v[100:103], v[68:71], v[36:39]
    ds_read_b128 v[56:59], v2 offset:2816
    v_mfma_f32_16x16x32_bf16 v[40:43], v[112:115], v[60:63], v[40:43]
    ds_read_b128 v[108:111], v1 offset:3840
    v_mfma_f32_16x16x32_bf16 v[40:43], v[104:107], v[68:71], v[40:43]
    s_waitcnt lgkmcnt(7)
    v_mfma_f32_16x16x32_bf16 v[40:43], v[100:103], v[116:119], v[40:43]
    v_mfma_f32_16x16x32_bf16 v[44:47], v[84:87], v[60:63], v[44:47]
    ds_read_b128 v[124:127], v2 offset:2304
    v_mfma_f32_16x16x32_bf16 v[44:47], v[112:115], v[68:71], v[44:47]
    ds_read_b128 v[88:91], v1 offset:2368
    v_mfma_f32_16x16x32_bf16 v[44:47], v[104:107], v[116:119], v[44:47]
    ds_read_b128 v[92:95], v2 offset:3904
    v_mfma_f32_16x16x32_bf16 v[44:47], v[100:103], v[96:99], v[44:47]
    ds_read_b128 v[84:87], v1 offset:2880
    s_waitcnt lgkmcnt(6)
    v_mfma_f32_16x16x32_bf16 v[32:35], v[80:83], v[64:67], v[32:35]
    ds_read_b128 v[60:63], v2 offset:3392
    v_mfma_f32_16x16x32_bf16 v[36:39], v[72:75], v[64:67], v[36:39]
    s_sub_u32 s21, s13, 2048
    s_waitcnt vmcnt(0)
    s_mov_b64 exec, 15
    s_cmp_eq_u32 s12, 0
    s_cbranch_scc0 L_ma_81
    buffer_store_dword v14, v11, s[80:83], s21 offen
L_mb_82:
    s_mov_b64 exec, -1
    ds_read_b128 v[112:115], v1 offset:3392
    v_mfma_f32_16x16x32_bf16 v[36:39], v[80:83], v[120:123], v[36:39]
    ds_read_b128 v[68:71], v2 offset:2880
    v_mfma_f32_16x16x32_bf16 v[40:43], v[76:79], v[64:67], v[40:43]
    ds_read_b128 v[104:107], v1 offset:3904
    v_mfma_f32_16x16x32_bf16 v[40:43], v[72:75], v[120:123], v[40:43]
    s_waitcnt lgkmcnt(7)
    v_mfma_f32_16x16x32_bf16 v[40:43], v[80:83], v[56:59], v[40:43]
    v_mfma_f32_16x16x32_bf16 v[44:47], v[108:111], v[64:67], v[44:47]
    ds_read_b128 v[116:119], v2 offset:2368
    v_mfma_f32_16x16x32_bf16 v[44:47], v[76:79], v[120:123], v[44:47]
    ds_read_b128 v[96:99], v1 offset:2432
    v_mfma_f32_16x16x32_bf16 v[44:47], v[72:75], v[56:59], v[44:47]
    ds_read_b128 v[100:103], v2 offset:3968
    v_mfma_f32_16x16x32_bf16 v[44:47], v[80:83], v[124:127], v[44:47]
    ds_read_b128 v[108:111], v1 offset:2944
    s_waitcnt lgkmcnt(6)
    v_mfma_f32_16x16x32_bf16 v[32:35], v[88:91], v[92:95], v[32:35]
    ds_read_b128 v[64:67], v2 offset:3456
    v_mfma_f32_16x16x32_bf16 v[36:39], v[84:87], v[92:95], v[36:39]
    ds_read_b128 v[76:79], v1 offset:3456
    v_mfma_f32_16x16x32_bf16 v[36:39], v[88:91], v[60:63], v[36:39]
    ds_read_b128 v[120:123], v2 offset:2944
    v_mfma_f32_16x16x32_bf16 v[40:43], v[112:115], v[92:95], v[40:43]
    ds_read_b128 v[72:75], v1 offset:3968
    v_mfma_f32_16x16x32_bf16 v[40:43], v[84:87], v[60:63], v[40:43]
    s_waitcnt lgkmcnt(7)
    v_mfma_f32_16x16x32_bf16 v[40:43], v[88:91], v[68:71], v[40:43]
    v_mfma_f32_16x16x32_bf16 v[44:47], v[104:107], v[92:95], v[44:47]
    ds_read_b128 v[56:59], v2 offset:2432
    v_mfma_f32_16x16x32_bf16 v[44:47], v[112:115], v[60:63], v[44:47]
    ds_read_b128 v[80:83], v1 offset:2496
    v_mfma_f32_16x16x32_bf16 v[44:47], v[84:87], v[68:71], v[44:47]
    ds_read_b128 v[124:127], v2 offset:4032
    v_mfma_f32_16x16x32_bf16 v[44:47], v[88:91], v[116:119], v[44:47]
    ds_read_b128 v[92:95], v1 offset:3008
    s_waitcnt lgkmcnt(6)
    v_mfma_f32_16x16x32_bf16 v[32:35], v[96:99], v[100:103], v[32:35]
    ds_read_b128 v[104:107], v2 offset:3520
    v_mfma_f32_16x16x32_bf16 v[36:39], v[108:111], v[100:103], v[36:39]
    ds_read_b128 v[112:115], v1 offset:3520
    v_mfma_f32_16x16x32_bf16 v[36:39], v[96:99], v[64:67], v[36:39]
    ds_read_b128 v[60:63], v2 offset:3008
    v_mfma_f32_16x16x32_bf16 v[40:43], v[76:79], v[100:103], v[40:43]
    ds_read_b128 v[84:87], v1 offset:4032
    v_mfma_f32_16x16x32_bf16 v[40:43], v[108:111], v[64:67], v[40:43]
    s_waitcnt lgkmcnt(7)
    v_mfma_f32_16x16x32_bf16 v[40:43], v[96:99], v[120:123], v[40:43]
    v_mfma_f32_16x16x32_bf16 v[44:47], v[72:75], v[100:103], v[44:47]
    ds_read_b128 v[68:71], v2 offset:2496
    v_mfma_f32_16x16x32_bf16 v[44:47], v[76:79], v[64:67], v[44:47]
    ds_read_b32 v12, v9 offset:36
    v_mfma_f32_16x16x32_bf16 v[44:47], v[108:111], v[120:123], v[44:47]
    ds_read_b128 v[88:91], v1 offset:0
    v_mfma_f32_16x16x32_bf16 v[44:47], v[96:99], v[56:59], v[44:47]
    s_waitcnt lgkmcnt(5)
    v_mfma_f32_16x16x32_bf16 v[32:35], v[80:83], v[124:127], v[32:35]
    v_mfma_f32_16x16x32_bf16 v[36:39], v[92:95], v[124:127], v[36:39]
    v_mfma_f32_16x16x32_bf16 v[36:39], v[80:83], v[104:107], v[36:39]
    s_waitcnt lgkmcnt(1)
    v_readfirstlane_b32 s8, v12
    s_cmp_ge_u32 s8, 4
    s_cbranch_scc0 L_ckc_84
L_ck_83:
    ds_read_b128 v[116:119], v2 offset:1536
    v_mfma_f32_16x16x32_bf16 v[40:43], v[112:115], v[124:127], v[40:43]
    ds_read_b128 v[72:75], v2 offset:1024
    v_mfma_f32_16x16x32_bf16 v[40:43], v[92:95], v[104:107], v[40:43]
    ds_read_b128 v[100:103], v1 offset:512
    v_mfma_f32_16x16x32_bf16 v[40:43], v[80:83], v[60:63], v[40:43]
    ds_read_b128 v[76:79], v2 offset:512
    v_mfma_f32_16x16x32_bf16 v[44:47], v[84:87], v[124:127], v[44:47]
    ds_read_b128 v[64:67], v1 offset:1024
    v_mfma_f32_16x16x32_bf16 v[44:47], v[112:115], v[104:107], v[44:47]
    ds_read_b128 v[108:111], v2 offset:0
    v_mfma_f32_16x16x32_bf16 v[44:47], v[92:95], v[60:63], v[44:47]
    ds_read_b128 v[120:123], v1 offset:1536
    v_mfma_f32_16x16x32_bf16 v[44:47], v[80:83], v[68:71], v[44:47]
    ds_read_b128 v[96:99], v1 offset:64
    s_waitcnt lgkmcnt(7)
    v_mfma_f32_16x16x32_bf16 v[32:35], v[88:91], v[116:119], v[32:35]
    ds_read_b128 v[56:59], v2 offset:1600
    s_waitcnt lgkmcnt(7)
    v_mfma_f32_16x16x32_bf16 v[36:39], v[88:91], v[72:75], v[36:39]
    ds_read_b128 v[84:87], v2 offset:1088
    s_waitcnt lgkmcnt(7)
    v_mfma_f32_16x16x32_bf16 v[36:39], v[100:103], v[116:119], v[36:39]
    ds_read_b128 v[124:127], v1 offset:576
    s_waitcnt lgkmcnt(7)
    v_mfma_f32_16x16x32_bf16 v[40:43], v[88:91], v[76:79], v[40:43]
    ds_read_b128 v[104:107], v2 offset:576
    v_mfma_f32_16x16x32_bf16 v[40:43], v[100:103], v[72:75], v[40:43]
    ds_read_b128 v[112:115], v1 offset:1088
    s_waitcnt lgkmcnt(8)
    v_mfma_f32_16x16x32_bf16 v[40:43], v[64:67], v[116:119], v[40:43]
    ds_read_b128 v[92:95], v2 offset:64
    s_waitcnt lgkmcnt(8)
    v_mfma_f32_16x16x32_bf16 v[44:47], v[88:91], v[108:111], v[44:47]
    ds_read_b128 v[60:63], v1 offset:1600
    v_mfma_f32_16x16x32_bf16 v[44:47], v[100:103], v[76:79], v[44:47]
    ds_read_b128 v[80:83], v1 offset:128
    v_mfma_f32_16x16x32_bf16 v[44:47], v[64:67], v[72:75], v[44:47]
    ds_read_b128 v[68:71], v2 offset:1664
    s_waitcnt lgkmcnt(8)
    v_mfma_f32_16x16x32_bf16 v[44:47], v[120:123], v[116:119], v[44:47]
    ds_read_b128 v[88:91], v2 offset:1152
    v_mfma_f32_16x16x32_bf16 v[32:35], v[96:99], v[56:59], v[32:35]
    ds_read_b128 v[108:111], v1 offset:640
    s_waitcnt lgkmcnt(8)
    v_mfma_f32_16x16x32_bf16 v[36:39], v[96:99], v[84:87], v[36:39]
    ds_read_b128 v[76:79], v2 offset:640
    v_mfma_f32_16x16x32_bf16 v[36:39], v[124:127], v[56:59], v[36:39]
    ds_read_b128 v[100:103], v1 offset:1152
    s_waitcnt lgkmcnt(8)
    v_mfma_f32_16x16x32_bf16 v[40:43], v[96:99], v[104:107], v[40:43]
    ds_read_b128 v[72:75], v2 offset:128
    v_mfma_f32_16x16x32_bf16 v[40:43], v[124:127], v[84:87], v[40:43]
    v_mfma_f32_16x16x32_bf16 v[40:43], v[112:115], v[56:59], v[40:43]
    s_waitcnt lgkmcnt(6)
    v_mfma_f32_16x16x32_bf16 v[44:47], v[96:99], v[92:95], v[44:47]
    ds_read_b128 v[64:67], v1 offset:1664
    v_mfma_f32_16x16x32_bf16 v[44:47], v[124:127], v[104:107], v[44:47]
    ds_read_b128 v[116:119], v1 offset:192
    v_mfma_f32_16x16x32_bf16 v[44:47], v[112:115], v[84:87], v[44:47]
    ds_read_b128 v[120:123], v2 offset:1728
    v_mfma_f32_16x16x32_bf16 v[44:47], v[60:63], v[56:59], v[44:47]
    ds_read_b128 v[92:95], v2 offset:1216
    s_waitcnt lgkmcnt(6)
    v_mfma_f32_16x16x32_bf16 v[32:35], v[80:83], v[68:71], v[32:35]
    ds_read_b128 v[96:99], v1 offset:704
    v_mfma_f32_16x16x32_bf16 v[36:39], v[80:83], v[88:91], v[36:39]
    ds_read_b128 v[104:107], v2 offset:704
    v_mfma_f32_16x16x32_bf16 v[36:39], v[108:111], v[68:71], v[36:39]
    ds_read_b128 v[124:127], v1 offset:1216
    v_mfma_f32_16x16x32_bf16 v[40:43], v[80:83], v[76:79], v[40:43]
    ds_read_b128 v[84:87], v2 offset:192
    v_mfma_f32_16x16x32_bf16 v[40:43], v[108:111], v[88:91], v[40:43]
    s_waitcnt lgkmcnt(7)
    v_mfma_f32_16x16x32_bf16 v[40:43], v[100:103], v[68:71], v[40:43]
    v_mfma_f32_16x16x32_bf16 v[44:47], v[80:83], v[72:75], v[44:47]
    ds_read_b128 v[112:115], v1 offset:1728
    v_mfma_f32_16x16x32_bf16 v[44:47], v[108:111], v[76:79], v[44:47]
    ds_read_b128 v[56:59], v1 offset:256
    v_mfma_f32_16x16x32_bf16 v[44:47], v[100:103], v[88:91], v[44:47]
    ds_read_b128 v[60:63], v2 offset:1792
    v_mfma_f32_16x16x32_bf16 v[44:47], v[64:67], v[68:71], v[44:47]
    ds_read_b128 v[72:75], v2 offset:1280
    s_waitcnt lgkmcnt(6)
    v_mfma_f32_16x16x32_bf16 v[32:35], v[116:119], v[120:123], v[32:35]
    ds_read_b128 v[80:83], v1 offset:768
    v_mfma_f32_16x16x32_bf16 v[36:39], v[116:119], v[92:95], v[36:39]
    ds_read_b128 v[76:79], v2 offset:768
    v_mfma_f32_16x16x32_bf16 v[36:39], v[96:99], v[120:123], v[36:39]
    ds_read_b128 v[108:111], v1 offset:1280
    v_mfma_f32_16x16x32_bf16 v[40:43], v[116:119], v[104:107], v[40:43]
    ds_read_b128 v[88:91], v2 offset:256
    v_mfma_f32_16x16x32_bf16 v[40:43], v[96:99], v[92:95], v[40:43]
    s_waitcnt lgkmcnt(7)
    v_mfma_f32_16x16x32_bf16 v[40:43], v[124:127], v[120:123], v[40:43]
    v_mfma_f32_16x16x32_bf16 v[44:47], v[116:119], v[84:87], v[44:47]
    ds_read_b128 v[100:103], v1 offset:1792
    v_mfma_f32_16x16x32_bf16 v[44:47], v[96:99], v[104:107], v[44:47]
    ds_read_b128 v[64:67], v1 offset:320
    v_mfma_f32_16x16x32_bf16 v[44:47], v[124:127], v[92:95], v[44:47]
    ds_read_b128 v[68:71], v2 offset:1856
    v_mfma_f32_16x16x32_bf16 v[44:47], v[112:115], v[120:123], v[44:47]
    ds_read_b128 v[84:87], v2 offset:1344
    s_waitcnt lgkmcnt(6)
    v_mfma_f32_16x16x32_bf16 v[32:35], v[56:59], v[60:63], v[32:35]
    ds_read_b128 v[116:119], v1 offset:832
    v_mfma_f32_16x16x32_bf16 v[36:39], v[56:59], v[72:75], v[36:39]
    ds_read_b128 v[96:99], v2 offset:832
    v_mfma_f32_16x16x32_bf16 v[36:39], v[80:83], v[60:63], v[36:39]
    ds_read_b128 v[104:107], v1 offset:1344
    v_mfma_f32_16x16x32_bf16 v[40:43], v[56:59], v[76:79], v[40:43]
    ds_read_b128 v[92:95], v2 offset:320
    v_mfma_f32_16x16x32_bf16 v[40:43], v[80:83], v[72:75], v[40:43]
    s_waitcnt lgkmcnt(7)
    v_mfma_f32_16x16x32_bf16 v[40:43], v[108:111], v[60:63], v[40:43]
    v_mfma_f32_16x16x32_bf16 v[44:47], v[56:59], v[88:91], v[44:47]
    ds_read_b128 v[124:127], v1 offset:1856
    v_mfma_f32_16x16x32_bf16 v[44:47], v[80:83], v[76:79], v[44:47]
    ds_read_b128 v[112:115], v1 offset:384
    v_mfma_f32_16x16x32_bf16 v[44:47], v[108:111], v[72:75], v[44:47]
    ds_read_b128 v[120:123], v2 offset:1920
    v_mfma_f32_16x16x32_bf16 v[44:47], v[100:103], v[60:63], v[44:47]
    ds_read_b128 v[88:91], v1 offset:448
    s_waitcnt lgkmcnt(6)
    v_mfma_f32_16x16x32_bf16 v[32:35], v[64:67], v[68:71], v[32:35]
    ds_read_b128 v[56:59], v2 offset:1984
    v_mfma_f32_16x16x32_bf16 v[36:39], v[64:67], v[84:87], v[36:39]
    ds_read_b128 v[76:79], v2 offset:1408
    v_mfma_f32_16x16x32_bf16 v[36:39], v[116:119], v[68:71], v[36:39]
    ds_read_b128 v[80:83], v1 offset:896
    v_mfma_f32_16x16x32_bf16 v[40:43], v[64:67], v[96:99], v[40:43]
    ds_read_b128 v[72:75], v2 offset:1472
    v_mfma_f32_16x16x32_bf16 v[40:43], v[116:119], v[84:87], v[40:43]
    ds_read_b128 v[108:111], v1 offset:960
    s_waitcnt lgkmcnt(8)
    v_mfma_f32_16x16x32_bf16 v[40:43], v[104:107], v[68:71], v[40:43]
    ds_read_b128 v[100:103], v2 offset:896
    v_mfma_f32_16x16x32_bf16 v[44:47], v[64:67], v[92:95], v[44:47]
    ds_read_b128 v[60:63], v1 offset:1408
    v_mfma_f32_16x16x32_bf16 v[44:47], v[116:119], v[96:99], v[44:47]
    ds_read_b128 v[92:95], v2 offset:960
    v_mfma_f32_16x16x32_bf16 v[44:47], v[104:107], v[84:87], v[44:47]
    ds_read_b128 v[64:67], v1 offset:1472
    v_mfma_f32_16x16x32_bf16 v[44:47], v[124:127], v[68:71], v[44:47]
    ds_read_b128 v[96:99], v2 offset:384
    s_waitcnt lgkmcnt(8)
    v_mfma_f32_16x16x32_bf16 v[32:35], v[112:115], v[120:123], v[32:35]
    v_mfma_f32_16x16x32_bf16 v[32:35], v[88:91], v[56:59], v[32:35]
    v_mfma_f32_16x16x32_bf16 v[36:39], v[112:115], v[76:79], v[36:39]
    ds_read_b128 v[116:119], v1 offset:1920
    s_waitcnt lgkmcnt(6)
    v_mfma_f32_16x16x32_bf16 v[36:39], v[80:83], v[120:123], v[36:39]
    ds_read_b128 v[84:87], v2 offset:448
    v_mfma_f32_16x16x32_bf16 v[36:39], v[88:91], v[72:75], v[36:39]
    v_mfma_f32_16x16x32_bf16 v[36:39], v[108:111], v[56:59], v[36:39]
    s_waitcnt lgkmcnt(4)
    v_mfma_f32_16x16x32_bf16 v[40:43], v[112:115], v[100:103], v[40:43]
    ds_read_b128 v[104:107], v1 offset:1984
    v_mfma_f32_16x16x32_bf16 v[40:43], v[80:83], v[76:79], v[40:43]
    v_mfma_f32_16x16x32_bf16 v[40:43], v[60:63], v[120:123], v[40:43]
    v_mfma_f32_16x16x32_bf16 v[40:43], v[88:91], v[92:95], v[40:43]
    v_cvt_pk_bf16_f32 v24, v32, v33
    v_mfma_f32_16x16x32_bf16 v[40:43], v[108:111], v[72:75], v[40:43]
    v_cvt_pk_bf16_f32 v25, v34, v35
    s_waitcnt lgkmcnt(2)
    v_mfma_f32_16x16x32_bf16 v[40:43], v[64:67], v[56:59], v[40:43]
    s_mov_b32 s9, 2359296
    s_cbranch_vccnz L_ys_85
    buffer_store_dwordx2 v[24:25], v5, s[72:75], s9 offen
L_yd_86:
    v_mfma_f32_16x16x32_bf16 v[44:47], v[112:115], v[96:99], v[44:47]
    v_mfma_f32_16x16x32_bf16 v[44:47], v[80:83], v[100:103], v[44:47]
    v_cvt_pk_bf16_f32 v26, v36, v37
    v_mfma_f32_16x16x32_bf16 v[44:47], v[60:63], v[76:79], v[44:47]
    v_cvt_pk_bf16_f32 v27, v38, v39
    v_mfma_f32_16x16x32_bf16 v[44:47], v[116:119], v[120:123], v[44:47]
    s_mov_b32 s9, 2949120
    s_cbranch_vccnz L_ys_87
    buffer_store_dwordx2 v[26:27], v5, s[72:75], s9 offen
L_yd_88:
    s_waitcnt lgkmcnt(0)
    v_mfma_f32_16x16x32_bf16 v[44:47], v[88:91], v[84:87], v[44:47]
    v_mfma_f32_16x16x32_bf16 v[44:47], v[108:111], v[92:95], v[44:47]
    v_mfma_f32_16x16x32_bf16 v[44:47], v[64:67], v[72:75], v[44:47]
    v_mfma_f32_16x16x32_bf16 v[44:47], v[104:107], v[56:59], v[44:47]
    v_cvt_pk_bf16_f32 v28, v40, v41
    v_cvt_pk_bf16_f32 v29, v42, v43
    s_mov_b32 s9, 3538944
    s_cbranch_vccnz L_ys_89
    buffer_store_dwordx2 v[28:29], v5, s[72:75], s9 offen
L_yd_90:
    s_nop 2
    v_cvt_pk_bf16_f32 v30, v44, v45
    v_cvt_pk_bf16_f32 v31, v46, v47
    s_mov_b32 s9, 4128768
    s_cbranch_vccnz L_ys_91
    buffer_store_dwordx2 v[30:31], v5, s[72:75], s9 offen
L_yd_92:
    s_waitcnt vmcnt(0)
    s_mov_b64 exec, 1
    ds_add_u32 v9, v10 offset:52
    s_mov_b64 exec, -1
    s_mov_b64 exec, 15
    s_cmp_eq_u32 s12, 0
    s_cbranch_scc0 L_ma_93
    buffer_store_dword v14, v11, s[80:83], s13 offen
L_mb_94:
    s_mov_b64 exec, -1
    s_endpgm
L_pgc_65:
    s_cmp_eq_u32 s12, 0
    s_cbranch_scc1 L_pgx_95
    s_mov_b64 exec, 1
    v_mov_b32 v80, 0
    buffer_atomic_add v80, off, s[60:63], s34 offset:4 sc0 sc1
    s_waitcnt vmcnt(0)
    v_readfirstlane_b32 s8, v80
    s_mov_b64 exec, -1
    s_cmp_ge_u32 s8, 128
    s_cbranch_scc1 L_pgd_64
L_pgr_66:
    s_cmp_lt_u32 s14, 32768
    s_cbranch_scc1 L_pg_63
    s_branch L_pgd_64
L_pgx_95:
    s_mov_b64 exec, -1
    ds_read_b32 v12, v9 offset:12
    s_waitcnt lgkmcnt(0)
    v_readfirstlane_b32 s8, v12
    s_cmp_eq_u32 s8, 0
    s_cbranch_scc0 L_dsw_96
    s_cmp_eq_u32 s35, 0
    s_cbranch_scc0 L_dnx_97
    s_sub_u32 s10, s26, s27
    s_sub_u32 s10, s10, 1
    s_mul_i32 s11, s10, s10
    s_lshl_b32 s11, s11, 16
    s_lshl_b32 s10, s10, 8
    s_add_u32 s10, s10, s11
    s_add_u32 s10, s10, 1
    s_lshl_b32 s11, s10, 5
    s_cmp_eq_u32 s14, 64
    s_cselect_b32 s10, s10, 0
    s_mov_b64 exec, 1
    v_mov_b32 v12, s10
    buffer_atomic_add v12, off, s[60:63], s34 sc0 sc1
    s_waitcnt vmcnt(0)
    v_readfirstlane_b32 s8, v12
    s_mov_b64 exec, -1
    s_add_u32 s8, s8, s10
    s_cmp_eq_u32 s8, s11
    s_cbranch_scc1 L_dnx_97
    s_and_b32 s8, s8, 0xff
    s_cmp_ge_u32 s8, 32
    s_cbranch_scc0 L_dnx_97
    ds_write_b32 v9, v10 offset:12
L_dsw_96:
    s_mov_b32 s12, 1
    s_mov_b32 s26, s27
    v_mov_b32 v14, s27
    s_add_u32 s33, s33, 16384
    s_mov_b64 s[68:69], s[44:45]
    s_add_u32 s72, s44, 4718592
    s_addc_u32 s73, s45, 0
    s_add_u32 s24, s24, 16384
    s_mov_b32 s19, s27
L_dnx_97:
    s_branch L_pgr_66
L_ckc_70:
    s_mov_b32 s14, 0
L_pl_98:
    ds_read_b32 v12, v9 offset:32
    s_add_u32 s14, s14, 1
    s_waitcnt lgkmcnt(0)
    v_readfirstlane_b32 s8, v12
    s_cmp_ge_u32 s8, 1
    s_cbranch_scc1 L_pld_99
    s_sleep 1
    s_cmp_lt_u32 s14, 131072
    s_cbranch_scc1 L_pl_98
L_pld_99:
    s_branch L_ck_69
L_ckc_72:
    s_mov_b32 s14, 0
L_pl_100:
    ds_read_b32 v12, v9 offset:16
    s_add_u32 s14, s14, 1
    s_waitcnt lgkmcnt(0)
    v_readfirstlane_b32 s8, v12
    s_cmp_ge_u32 s8, 4
    s_cbranch_scc1 L_pld_101
    s_sleep 1
    s_cmp_lt_u32 s14, 131072
    s_cbranch_scc1 L_pl_100
L_pld_101:
    s_branch L_ck_71
L_ys_73:
    buffer_store_dwordx2 v[48:49], v5, s[72:75], s9 offen sc1
    s_branch L_yd_74
L_ys_75:
    buffer_store_dwordx2 v[50:51], v5, s[72:75], s9 offen sc1
    s_branch L_yd_76
L_ys_77:
    buffer_store_dwordx2 v[52:53], v5, s[72:75], s9 offen sc1
    s_branch L_yd_78
L_ys_79:
    buffer_store_dwordx2 v[54:55], v5, s[72:75], s9 offen sc1
    s_branch L_yd_80
L_ma_81:
    s_mov_b64 exec, 1
    v_mov_b32 v16, 1
    buffer_atomic_add v16, off, s[60:63], s34 offset:8 sc0 sc1
    s_waitcnt vmcnt(0)
    v_readfirstlane_b32 s8, v16
    s_cmp_eq_u32 s8, 127
    s_cbranch_scc0 L_mb_82
    s_mov_b64 exec, -1
    s_add_u32 s9, s33, 4096
    v_lshlrev_b32 v20, 4, v0
    v_mov_b32 v16, v14
    v_mov_b32 v17, v14
    v_mov_b32 v18, v14
    v_mov_b32 v19, v14
    buffer_store_dwordx4 v[16:19], v20, s[80:83], s9 offen offset:0 sc1
    buffer_store_dwordx4 v[16:19], v20, s[80:83], s9 offen offset:1024 sc1
    buffer_store_dwordx4 v[16:19], v20, s[80:83], s9 offen offset:0
    buffer_store_dwordx4 v[16:19], v20, s[80:83], s9 offen offset:1024
    s_branch L_mb_82
L_ckc_84:
    s_mov_b32 s14, 0
L_pl_102:
    ds_read_b32 v12, v9 offset:36
    s_add_u32 s14, s14, 1
    s_waitcnt lgkmcnt(0)
    v_readfirstlane_b32 s8, v12
    s_cmp_ge_u32 s8, 4
    s_cbranch_scc1 L_pld_103
    s_sleep 1
    s_cmp_lt_u32 s14, 131072
    s_cbranch_scc1 L_pl_102
L_pld_103:
    s_branch L_ck_83
L_ys_85:
    buffer_store_dwordx2 v[24:25], v5, s[72:75], s9 offen sc1
    s_branch L_yd_86
L_ys_87:
    buffer_store_dwordx2 v[26:27], v5, s[72:75], s9 offen sc1
    s_branch L_yd_88
L_ys_89:
    buffer_store_dwordx2 v[28:29], v5, s[72:75], s9 offen sc1
    s_branch L_yd_90
L_ys_91:
    buffer_store_dwordx2 v[30:31], v5, s[72:75], s9 offen sc1
    s_branch L_yd_92
L_ma_93:
    s_mov_b64 exec, 1
    v_mov_b32 v16, 1
    buffer_atomic_add v16, off, s[60:63], s34 offset:12 sc0 sc1
    s_waitcnt vmcnt(0)
    v_readfirstlane_b32 s8, v16
    s_cmp_eq_u32 s8, 127
    s_cbranch_scc0 L_mb_94
    s_mov_b64 exec, -1
    s_add_u32 s9, s33, 6144
    v_lshlrev_b32 v20, 4, v0
    v_mov_b32 v16, v14
    v_mov_b32 v17, v14
    v_mov_b32 v18, v14
    v_mov_b32 v19, v14
    buffer_store_dwordx4 v[16:19], v20, s[80:83], s9 offen offset:0 sc1
    buffer_store_dwordx4 v[16:19], v20, s[80:83], s9 offen offset:1024 sc1
    buffer_store_dwordx4 v[16:19], v20, s[80:83], s9 offen offset:0
    buffer_store_dwordx4 v[16:19], v20, s[80:83], s9 offen offset:1024
    s_branch L_mb_94
L_C1:
    ds_read_b128 v[72:75], v1 offset:0
    ds_read_b128 v[84:87], v1 offset:512
    s_waitcnt vmcnt(1)
    ds_write_b128 v52, v[64:67] offset:0
    ds_write2_b64 v53, v[64:65], v[66:67] offset0:0 offset1:1
    s_waitcnt vmcnt(0)
    ds_write_b128 v52, v[68:71] offset:256
    ds_write2_b64 v53, v[68:69], v[70:71] offset0:32 offset1:33
    s_waitcnt lgkmcnt(0)
    s_mov_b64 exec, 1
    ds_add_u32 v9, v10 offset:40
    s_mov_b64 exec, -1
    s_mov_b32 s14, 0
L_pl_104:
    ds_read_b32 v12, v9 offset:40
    s_add_u32 s14, s14, 1
    s_waitcnt lgkmcnt(0)
    v_readfirstlane_b32 s8, v12
    s_cmp_ge_u32 s8, 4
    s_cbranch_scc1 L_pld_105
    s_cmp_lt_u32 s14, 131072
    s_cbranch_scc1 L_pl_104
L_pld_105:
    ds_read_b128 v[76:79], v2 offset:3584
    ds_read_b128 v[80:83], v2 offset:3072
    ds_read_b128 v[88:91], v2 offset:2560
    s_waitcnt lgkmcnt(2)
    v_mfma_f32_16x16x32_bf16 v[16:19], v[72:75], v[76:79], 0
    ds_read_b128 v[92:95], v1 offset:1024
    s_waitcnt lgkmcnt(2)
    v_mfma_f32_16x16x32_bf16 v[20:23], v[72:75], v[80:83], 0
    ds_read_b128 v[96:99], v2 offset:2048
    v_mfma_f32_16x16x32_bf16 v[20:23], v[84:87], v[76:79], v[20:23]
    ds_read_b128 v[100:103], v1 offset:1536
    v_mfma_f32_16x16x32_bf16 v[24:27], v[84:87], v[80:83], 0
    ds_read_b128 v[104:107], v1 offset:64
    s_waitcnt lgkmcnt(4)
    v_mfma_f32_16x16x32_bf16 v[24:27], v[72:75], v[88:91], v[24:27]
    ds_read_b128 v[108:111], v2 offset:3648
    s_waitcnt lgkmcnt(4)
    v_mfma_f32_16x16x32_bf16 v[24:27], v[92:95], v[76:79], v[24:27]
    ds_read_b128 v[112:115], v2 offset:3136
    v_mfma_f32_16x16x32_bf16 v[28:31], v[84:87], v[88:91], 0
    ds_read_b128 v[116:119], v1 offset:576
    v_mfma_f32_16x16x32_bf16 v[28:31], v[92:95], v[80:83], v[28:31]
    ds_read_b128 v[120:123], v2 offset:2624
    v_mfma_f32_16x16x32_bf16 v[32:35], v[92:95], v[88:91], 0
    ds_read_b128 v[124:127], v1 offset:1088
    s_waitcnt lgkmcnt(7)
    v_mfma_f32_16x16x32_bf16 v[28:31], v[72:75], v[96:99], v[28:31]
    s_waitcnt lgkmcnt(6)
    v_mfma_f32_16x16x32_bf16 v[28:31], v[100:103], v[76:79], v[28:31]
    v_mfma_f32_16x16x32_bf16 v[32:35], v[84:87], v[96:99], v[32:35]
    v_mfma_f32_16x16x32_bf16 v[32:35], v[100:103], v[80:83], v[32:35]
    ds_read_b128 v[72:75], v2 offset:2112
    v_mfma_f32_16x16x32_bf16 v[36:39], v[92:95], v[96:99], 0
    ds_read_b128 v[76:79], v1 offset:1600
    v_mfma_f32_16x16x32_bf16 v[36:39], v[100:103], v[88:91], v[36:39]
    v_mfma_f32_16x16x32_bf16 v[40:43], v[100:103], v[96:99], 0
    s_waitcnt lgkmcnt(3)
    v_mfma_f32_16x16x32_bf16 v[16:19], v[104:107], v[108:111], v[16:19]
    v_mfma_f32_16x16x32_bf16 v[20:23], v[104:107], v[112:115], v[20:23]
    v_mfma_f32_16x16x32_bf16 v[20:23], v[116:119], v[108:111], v[20:23]
    v_mfma_f32_16x16x32_bf16 v[24:27], v[116:119], v[112:115], v[24:27]
    ds_read_b128 v[84:87], v1 offset:128
    v_mfma_f32_16x16x32_bf16 v[24:27], v[104:107], v[120:123], v[24:27]
    ds_read_b128 v[80:83], v2 offset:3712
    s_waitcnt lgkmcnt(3)
    v_mfma_f32_16x16x32_bf16 v[24:27], v[124:127], v[108:111], v[24:27]
    ds_read_b128 v[92:95], v2 offset:3200
    v_mfma_f32_16x16x32_bf16 v[28:31], v[116:119], v[120:123], v[28:31]
    ds_read_b128 v[88:91], v1 offset:640
    v_mfma_f32_16x16x32_bf16 v[28:31], v[124:127], v[112:115], v[28:31]
    ds_read_b128 v[96:99], v2 offset:2688
    v_mfma_f32_16x16x32_bf16 v[32:35], v[124:127], v[120:123], v[32:35]
    ds_read_b128 v[100:103], v1 offset:1152
    v_mfma_f32_16x16x32_bf16 v[28:31], v[104:107], v[72:75], v[28:31]
    s_waitcnt lgkmcnt(6)
    v_mfma_f32_16x16x32_bf16 v[28:31], v[76:79], v[108:111], v[28:31]
    v_mfma_f32_16x16x32_bf16 v[32:35], v[116:119], v[72:75], v[32:35]
    v_mfma_f32_16x16x32_bf16 v[32:35], v[76:79], v[112:115], v[32:35]
    ds_read_b128 v[104:107], v2 offset:2176
    v_mfma_f32_16x16x32_bf16 v[36:39], v[124:127], v[72:75], v[36:39]
    ds_read_b128 v[108:111], v1 offset:1664
    v_mfma_f32_16x16x32_bf16 v[36:39], v[76:79], v[120:123], v[36:39]
    v_mfma_f32_16x16x32_bf16 v[40:43], v[76:79], v[72:75], v[40:43]
    s_waitcnt lgkmcnt(3)
    v_mfma_f32_16x16x32_bf16 v[16:19], v[84:87], v[80:83], v[16:19]
    v_mfma_f32_16x16x32_bf16 v[20:23], v[84:87], v[92:95], v[20:23]
    v_mfma_f32_16x16x32_bf16 v[20:23], v[88:91], v[80:83], v[20:23]
    v_mfma_f32_16x16x32_bf16 v[24:27], v[88:91], v[92:95], v[24:27]
    ds_read_b128 v[116:119], v1 offset:192
    v_mfma_f32_16x16x32_bf16 v[24:27], v[84:87], v[96:99], v[24:27]
    ds_read_b128 v[112:115], v2 offset:3776
    s_waitcnt lgkmcnt(3)
    v_mfma_f32_16x16x32_bf16 v[24:27], v[100:103], v[80:83], v[24:27]
    ds_read_b128 v[124:127], v2 offset:3264
    v_mfma_f32_16x16x32_bf16 v[28:31], v[88:91], v[96:99], v[28:31]
    ds_read_b128 v[120:123], v1 offset:704
    v_mfma_f32_16x16x32_bf16 v[28:31], v[100:103], v[92:95], v[28:31]
    ds_read_b128 v[72:75], v2 offset:2752
    v_mfma_f32_16x16x32_bf16 v[32:35], v[100:103], v[96:99], v[32:35]
    ds_read_b128 v[76:79], v1 offset:1216
    v_mfma_f32_16x16x32_bf16 v[28:31], v[84:87], v[104:107], v[28:31]
    s_waitcnt lgkmcnt(6)
    v_mfma_f32_16x16x32_bf16 v[28:31], v[108:111], v[80:83], v[28:31]
    v_mfma_f32_16x16x32_bf16 v[32:35], v[88:91], v[104:107], v[32:35]
    v_mfma_f32_16x16x32_bf16 v[32:35], v[108:111], v[92:95], v[32:35]
    ds_read_b128 v[84:87], v2 offset:2240
    v_mfma_f32_16x16x32_bf16 v[36:39], v[100:103], v[104:107], v[36:39]
    ds_read_b128 v[80:83], v1 offset:1728
    v_mfma_f32_16x16x32_bf16 v[36:39], v[108:111], v[96:99], v[36:39]
    v_mfma_f32_16x16x32_bf16 v[40:43], v[108:111], v[104:107], v[40:43]
    s_waitcnt lgkmcnt(3)
    v_mfma_f32_16x16x32_bf16 v[16:19], v[116:119], v[112:115], v[16:19]
    v_mfma_f32_16x16x32_bf16 v[20:23], v[116:119], v[124:127], v[20:23]
    v_mfma_f32_16x16x32_bf16 v[20:23], v[120:123], v[112:115], v[20:23]
    v_mfma_f32_16x16x32_bf16 v[24:27], v[120:123], v[124:127], v[24:27]
    ds_read_b128 v[88:91], v1 offset:256
    v_mfma_f32_16x16x32_bf16 v[24:27], v[116:119], v[72:75], v[24:27]
    ds_read_b128 v[92:95], v2 offset:3840
    s_waitcnt lgkmcnt(3)
    v_mfma_f32_16x16x32_bf16 v[24:27], v[76:79], v[112:115], v[24:27]
    ds_read_b128 v[100:103], v2 offset:3328
    v_mfma_f32_16x16x32_bf16 v[28:31], v[120:123], v[72:75], v[28:31]
    ds_read_b128 v[96:99], v1 offset:768
    v_mfma_f32_16x16x32_bf16 v[28:31], v[76:79], v[124:127], v[28:31]
    ds_read_b128 v[104:107], v2 offset:2816
    v_mfma_f32_16x16x32_bf16 v[32:35], v[76:79], v[72:75], v[32:35]
    ds_read_b128 v[108:111], v1 offset:1280
    v_mfma_f32_16x16x32_bf16 v[28:31], v[116:119], v[84:87], v[28:31]
    s_waitcnt lgkmcnt(6)
    v_mfma_f32_16x16x32_bf16 v[28:31], v[80:83], v[112:115], v[28:31]
    v_mfma_f32_16x16x32_bf16 v[32:35], v[120:123], v[84:87], v[32:35]
    v_mfma_f32_16x16x32_bf16 v[32:35], v[80:83], v[124:127], v[32:35]
    ds_read_b128 v[116:119], v2 offset:2304
    v_mfma_f32_16x16x32_bf16 v[36:39], v[76:79], v[84:87], v[36:39]
    ds_read_b128 v[112:115], v1 offset:1792
    v_mfma_f32_16x16x32_bf16 v[36:39], v[80:83], v[72:75], v[36:39]
    v_mfma_f32_16x16x32_bf16 v[40:43], v[80:83], v[84:87], v[40:43]
    s_waitcnt lgkmcnt(3)
    v_mfma_f32_16x16x32_bf16 v[16:19], v[88:91], v[92:95], v[16:19]
    v_mfma_f32_16x16x32_bf16 v[20:23], v[88:91], v[100:103], v[20:23]
    v_mfma_f32_16x16x32_bf16 v[20:23], v[96:99], v[92:95], v[20:23]
    v_mfma_f32_16x16x32_bf16 v[24:27], v[96:99], v[100:103], v[24:27]
    ds_read_b128 v[120:123], v1 offset:320
    v_mfma_f32_16x16x32_bf16 v[24:27], v[88:91], v[104:107], v[24:27]
    ds_read_b128 v[124:127], v2 offset:3904
    s_waitcnt lgkmcnt(3)
    v_mfma_f32_16x16x32_bf16 v[24:27], v[108:111], v[92:95], v[24:27]
    ds_read_b128 v[76:79], v2 offset:3392
    v_mfma_f32_16x16x32_bf16 v[28:31], v[96:99], v[104:107], v[28:31]
    ds_read_b128 v[72:75], v1 offset:832
    v_mfma_f32_16x16x32_bf16 v[28:31], v[108:111], v[100:103], v[28:31]
    ds_read_b128 v[80:83], v2 offset:2880
    v_mfma_f32_16x16x32_bf16 v[32:35], v[108:111], v[104:107], v[32:35]
    ds_read_b128 v[84:87], v1 offset:1344
    v_mfma_f32_16x16x32_bf16 v[28:31], v[88:91], v[116:119], v[28:31]
    s_waitcnt lgkmcnt(6)
    v_mfma_f32_16x16x32_bf16 v[28:31], v[112:115], v[92:95], v[28:31]
    v_mfma_f32_16x16x32_bf16 v[32:35], v[96:99], v[116:119], v[32:35]
    v_mfma_f32_16x16x32_bf16 v[32:35], v[112:115], v[100:103], v[32:35]
    ds_read_b128 v[88:91], v2 offset:2368
    v_mfma_f32_16x16x32_bf16 v[36:39], v[108:111], v[116:119], v[36:39]
    ds_read_b128 v[92:95], v1 offset:1856
    v_mfma_f32_16x16x32_bf16 v[36:39], v[112:115], v[104:107], v[36:39]
    v_mfma_f32_16x16x32_bf16 v[40:43], v[112:115], v[116:119], v[40:43]
    s_waitcnt lgkmcnt(3)
    v_mfma_f32_16x16x32_bf16 v[16:19], v[120:123], v[124:127], v[16:19]
    v_mfma_f32_16x16x32_bf16 v[20:23], v[120:123], v[76:79], v[20:23]
    v_mfma_f32_16x16x32_bf16 v[20:23], v[72:75], v[124:127], v[20:23]
    v_mfma_f32_16x16x32_bf16 v[24:27], v[72:75], v[76:79], v[24:27]
    v_mfma_f32_16x16x32_bf16 v[24:27], v[120:123], v[80:83], v[24:27]
    ds_read_b32 v12, v9 offset:32
    s_waitcnt lgkmcnt(2)
    v_mfma_f32_16x16x32_bf16 v[24:27], v[84:87], v[124:127], v[24:27]
    v_mfma_f32_16x16x32_bf16 v[28:31], v[72:75], v[80:83], v[28:31]
    v_mfma_f32_16x16x32_bf16 v[28:31], v[84:87], v[76:79], v[28:31]
    v_mfma_f32_16x16x32_bf16 v[32:35], v[84:87], v[80:83], v[32:35]
    v_mfma_f32_16x16x32_bf16 v[28:31], v[120:123], v[88:91], v[28:31]
    s_waitcnt lgkmcnt(0)
    v_readfirstlane_b32 s8, v12
    s_cmp_ge_u32 s8, 1
    s_cbranch_scc0 L_ckc_107
L_ck_106:
    ds_read_b128 v[96:99], v3 offset:2048
    v_mfma_f32_16x16x32_bf16 v[28:31], v[92:95], v[124:127], v[28:31]
    ds_read_b128 v[100:103], v4 offset:3072
    v_mfma_f32_16x16x32_bf16 v[32:35], v[72:75], v[88:91], v[32:35]
    ds_read_b128 v[108:111], v4 offset:2560
    v_mfma_f32_16x16x32_bf16 v[32:35], v[92:95], v[76:79], v[32:35]
    ds_read_b128 v[104:107], v3 offset:2560
    v_mfma_f32_16x16x32_bf16 v[36:39], v[84:87], v[88:91], v[36:39]
    ds_read_b128 v[112:115], v4 offset:3584
    v_mfma_f32_16x16x32_bf16 v[36:39], v[92:95], v[80:83], v[36:39]
    ds_read_b128 v[116:119], v3 offset:3072
    v_mfma_f32_16x16x32_bf16 v[40:43], v[92:95], v[88:91], v[40:43]
    ds_read_b128 v[120:123], v3 offset:0
    s_waitcnt lgkmcnt(5)
    v_mfma_f32_16x16x32_bf16 v[56:59], v[96:99], v[100:103], 0
    ds_read_b128 v[124:127], v3 offset:512
    s_waitcnt lgkmcnt(5)
    v_mfma_f32_16x16x32_bf16 v[60:63], v[96:99], v[108:111], 0
    ds_read_b128 v[72:75], v3 offset:1024
    s_waitcnt lgkmcnt(4)
    v_mfma_f32_16x16x32_bf16 v[56:59], v[104:107], v[112:115], v[56:59]
    ds_read_b128 v[76:79], v4 offset:2048
    v_mfma_f32_16x16x32_bf16 v[60:63], v[104:107], v[100:103], v[60:63]
    ds_read_b128 v[84:87], v3 offset:1536
    s_waitcnt lgkmcnt(5)
    v_mfma_f32_16x16x32_bf16 v[60:63], v[116:119], v[112:115], v[60:63]
    ds_read_b128 v[80:83], v4 offset:1024
    s_waitcnt lgkmcnt(5)
    v_mfma_f32_16x16x32_bf16 v[64:67], v[120:123], v[100:103], 0
    ds_read_b128 v[88:91], v4 offset:512
    v_mfma_f32_16x16x32_bf16 v[68:71], v[120:123], v[108:111], 0
    ds_read_b128 v[92:95], v4 offset:1536
    s_waitcnt lgkmcnt(6)
    v_mfma_f32_16x16x32_bf16 v[64:67], v[124:127], v[112:115], v[64:67]
    ds_read_b128 v[96:99], v3 offset:2112
    v_mfma_f32_16x16x32_bf16 v[68:71], v[124:127], v[100:103], v[68:71]
    ds_read_b128 v[104:107], v4 offset:3136
    s_waitcnt lgkmcnt(7)
    v_mfma_f32_16x16x32_bf16 v[68:71], v[72:75], v[112:115], v[68:71]
    ds_read_b128 v[116:119], v4 offset:2624
    s_waitcnt lgkmcnt(7)
    v_mfma_f32_16x16x32_bf16 v[56:59], v[72:75], v[76:79], v[56:59]
    ds_read_b128 v[100:103], v3 offset:2624
    s_waitcnt lgkmcnt(7)
    v_mfma_f32_16x16x32_bf16 v[56:59], v[84:87], v[108:111], v[56:59]
    ds_read_b128 v[112:115], v4 offset:3648
    v_mfma_f32_16x16x32_bf16 v[60:63], v[84:87], v[76:79], v[60:63]
    ds_read_b128 v[108:111], v3 offset:3136
    s_waitcnt lgkmcnt(8)
    v_mfma_f32_16x16x32_bf16 v[56:59], v[120:123], v[80:83], v[56:59]
    ds_read_b128 v[76:79], v3 offset:64
    s_waitcnt lgkmcnt(8)
    v_mfma_f32_16x16x32_bf16 v[60:63], v[120:123], v[88:91], v[60:63]
    ds_read_b128 v[84:87], v3 offset:576
    s_waitcnt lgkmcnt(8)
    v_mfma_f32_16x16x32_bf16 v[56:59], v[124:127], v[92:95], v[56:59]
    ds_read_b128 v[88:91], v3 offset:1088
    v_mfma_f32_16x16x32_bf16 v[60:63], v[124:127], v[80:83], v[60:63]
    ds_read_b128 v[120:123], v4 offset:2112
    v_mfma_f32_16x16x32_bf16 v[60:63], v[72:75], v[92:95], v[60:63]
    ds_read_b128 v[80:83], v3 offset:1600
    s_waitcnt lgkmcnt(8)
    v_mfma_f32_16x16x32_bf16 v[56:59], v[96:99], v[104:107], v[56:59]
    ds_read_b128 v[124:127], v4 offset:1088
    v_mfma_f32_16x16x32_bf16 v[60:63], v[96:99], v[116:119], v[60:63]
    ds_read_b128 v[72:75], v4 offset:576
    s_waitcnt lgkmcnt(8)
    v_mfma_f32_16x16x32_bf16 v[56:59], v[100:103], v[112:115], v[56:59]
    ds_read_b128 v[92:95], v4 offset:1600
    v_mfma_f32_16x16x32_bf16 v[60:63], v[100:103], v[104:107], v[60:63]
    s_waitcnt lgkmcnt(7)
    v_mfma_f32_16x16x32_bf16 v[60:63], v[108:111], v[112:115], v[60:63]
    v_mfma_f32_16x16x32_bf16 v[64:67], v[76:79], v[104:107], v[64:67]
    ds_read_b128 v[96:99], v1 offset:384
    v_mfma_f32_16x16x32_bf16 v[68:71], v[76:79], v[116:119], v[68:71]
    ds_read_b128 v[100:103], v2 offset:3968
    s_waitcnt lgkmcnt(6)
    v_mfma_f32_16x16x32_bf16 v[64:67], v[84:87], v[112:115], v[64:67]
    ds_read_b128 v[108:111], v2 offset:3456
    v_mfma_f32_16x16x32_bf16 v[68:71], v[84:87], v[104:107], v[68:71]
    ds_read_b128 v[104:107], v1 offset:896
    v_mfma_f32_16x16x32_bf16 v[68:71], v[88:91], v[112:115], v[68:71]
    ds_read_b128 v[112:115], v2 offset:2944
    v_mfma_f32_16x16x32_bf16 v[56:59], v[88:91], v[120:123], v[56:59]
    s_waitcnt lgkmcnt(5)
    v_mfma_f32_16x16x32_bf16 v[56:59], v[80:83], v[116:119], v[56:59]
    ds_read_b128 v[116:119], v1 offset:1408
    v_mfma_f32_16x16x32_bf16 v[60:63], v[80:83], v[120:123], v[60:63]
    v_mfma_f32_16x16x32_bf16 v[56:59], v[76:79], v[124:127], v[56:59]
    v_mfma_f32_16x16x32_bf16 v[60:63], v[76:79], v[72:75], v[60:63]
    ds_read_b128 v[80:83], v2 offset:2432
    v_mfma_f32_16x16x32_bf16 v[56:59], v[84:87], v[92:95], v[56:59]
    ds_read_b128 v[120:123], v1 offset:1920
    v_mfma_f32_16x16x32_bf16 v[60:63], v[84:87], v[124:127], v[60:63]
    v_mfma_f32_16x16x32_bf16 v[60:63], v[88:91], v[92:95], v[60:63]
    s_waitcnt lgkmcnt(3)
    v_mfma_f32_16x16x32_bf16 v[16:19], v[96:99], v[100:103], v[16:19]
    v_mfma_f32_16x16x32_bf16 v[20:23], v[96:99], v[108:111], v[20:23]
    v_mfma_f32_16x16x32_bf16 v[20:23], v[104:107], v[100:103], v[20:23]
    ds_read_b32 v12, v9 offset:16
    v_mfma_f32_16x16x32_bf16 v[24:27], v[104:107], v[108:111], v[24:27]
    ds_read_b128 v[72:75], v1 offset:448
    v_mfma_f32_16x16x32_bf16 v[24:27], v[96:99], v[112:115], v[24:27]
    ds_read_b128 v[76:79], v2 offset:4032
    s_waitcnt lgkmcnt(4)
    v_mfma_f32_16x16x32_bf16 v[24:27], v[116:119], v[100:103], v[24:27]
    ds_read_b128 v[84:87], v2 offset:3520
    v_mfma_f32_16x16x32_bf16 v[28:31], v[104:107], v[112:115], v[28:31]
    ds_read_b128 v[124:127], v1 offset:960
    v_mfma_f32_16x16x32_bf16 v[28:31], v[116:119], v[108:111], v[28:31]
    s_waitcnt lgkmcnt(4)
    v_readfirstlane_b32 s8, v12
    s_cmp_ge_u32 s8, 4
    s_cbranch_scc0 L_ckc_109
L_ck_108:
    ds_write_b128 v7, v[64:67] offset:0
    v_mfma_f32_16x16x32_bf16 v[32:35], v[116:119], v[112:115], v[32:35]
    ds_write_b128 v7, v[68:71] offset:4096
    v_mfma_f32_16x16x32_bf16 v[28:31], v[96:99], v[80:83], v[28:31]
    ds_write_b128 v7, v[56:59] offset:8192
    v_mfma_f32_16x16x32_bf16 v[28:31], v[120:123], v[100:103], v[28:31]
    ds_write_b128 v7, v[60:63] offset:12288
    v_mfma_f32_16x16x32_bf16 v[32:35], v[104:107], v[80:83], v[32:35]
    ds_read_b128 v[88:91], v2 offset:3008
    v_mfma_f32_16x16x32_bf16 v[32:35], v[120:123], v[108:111], v[32:35]
    ds_read_b128 v[92:95], v1 offset:1472
    v_mfma_f32_16x16x32_bf16 v[36:39], v[116:119], v[80:83], v[36:39]
    ds_read_b128 v[96:99], v2 offset:2496
    v_mfma_f32_16x16x32_bf16 v[36:39], v[120:123], v[112:115], v[36:39]
    ds_read_b128 v[100:103], v1 offset:1984
    v_mfma_f32_16x16x32_bf16 v[40:43], v[120:123], v[80:83], v[40:43]
    s_waitcnt lgkmcnt(4)
    s_mov_b64 exec, 1
    ds_add_u32 v9, v10 offset:44
    s_mov_b64 exec, -1
    v_mfma_f32_16x16x32_bf16 v[16:19], v[72:75], v[76:79], v[16:19]
    v_mfma_f32_16x16x32_bf16 v[20:23], v[72:75], v[84:87], v[20:23]
    v_mfma_f32_16x16x32_bf16 v[20:23], v[124:127], v[76:79], v[20:23]
    v_mfma_f32_16x16x32_bf16 v[24:27], v[124:127], v[84:87], v[24:27]
    ds_read_b128 v[104:107], v1 offset:2048
    s_waitcnt lgkmcnt(5)
    v_mfma_f32_16x16x32_bf16 v[24:27], v[72:75], v[88:91], v[24:27]
    ds_read_b128 v[108:111], v2 offset:3584
    s_waitcnt lgkmcnt(5)
    v_mfma_f32_16x16x32_bf16 v[24:27], v[92:95], v[76:79], v[24:27]
    ds_read_b128 v[116:119], v1 offset:2560
    v_mfma_f32_16x16x32_bf16 v[28:31], v[124:127], v[88:91], v[28:31]
    ds_read_b128 v[112:115], v2 offset:3072
    v_mfma_f32_16x16x32_bf16 v[28:31], v[92:95], v[84:87], v[28:31]
    ds_read_b128 v[80:83], v1 offset:3072
    s_waitcnt lgkmcnt(5)
    v_mfma_f32_16x16x32_bf16 v[28:31], v[72:75], v[96:99], v[28:31]
    v_cvt_pk_bf16_f32 v48, v16, v17
    ds_read_b128 v[120:123], v2 offset:2560
    v_mfma_f32_16x16x32_bf16 v[28:31], v[100:103], v[76:79], v[28:31]
    v_cvt_pk_bf16_f32 v49, v18, v19
    ds_read_b128 v[56:59], v1 offset:3584
    v_mfma_f32_16x16x32_bf16 v[32:35], v[92:95], v[88:91], v[32:35]
    v_cvt_pk_bf16_f32 v50, v20, v21
    v_mfma_f32_16x16x32_bf16 v[32:35], v[124:127], v[96:99], v[32:35]
    v_cvt_pk_bf16_f32 v51, v22, v23
    v_mfma_f32_16x16x32_bf16 v[32:35], v[100:103], v[84:87], v[32:35]
    ds_read_b128 v[60:63], v2 offset:2048
    v_mfma_f32_16x16x32_bf16 v[36:39], v[92:95], v[96:99], v[36:39]
    v_cvt_pk_bf16_f32 v52, v24, v25
    ds_read_b128 v[64:67], v1 offset:2112
    v_mfma_f32_16x16x32_bf16 v[36:39], v[100:103], v[88:91], v[36:39]
    v_cvt_pk_bf16_f32 v53, v26, v27
    ds_read_b128 v[68:71], v2 offset:3648
    v_mfma_f32_16x16x32_bf16 v[40:43], v[100:103], v[96:99], v[40:43]
    ds_read_b128 v[72:75], v1 offset:2624
    s_waitcnt lgkmcnt(6)
    v_mfma_f32_16x16x32_bf16 v[32:35], v[104:107], v[108:111], v[32:35]
    ds_read_b128 v[76:79], v2 offset:3136
    v_mfma_f32_16x16x32_bf16 v[36:39], v[116:119], v[108:111], v[36:39]
    v_cvt_pk_bf16_f32 v54, v28, v29
    ds_read_b128 v[124:127], v1 offset:3136
    v_mfma_f32_16x16x32_bf16 v[36:39], v[104:107], v[112:115], v[36:39]
    v_cvt_pk_bf16_f32 v55, v30, v31
    ds_read_b128 v[84:87], v2 offset:2624
    v_mfma_f32_16x16x32_bf16 v[40:43], v[80:83], v[108:111], v[40:43]
    s_mov_b32 s9, 0
    s_cbranch_vccnz L_ys_110
    buffer_store_dwordx2 v[48:49], v5, s[72:75], s9 offen
L_yd_111:
    ds_read_b128 v[92:95], v1 offset:3648
    v_mfma_f32_16x16x32_bf16 v[40:43], v[116:119], v[112:115], v[40:43]
    s_waitcnt lgkmcnt(7)
    v_mfma_f32_16x16x32_bf16 v[40:43], v[104:107], v[120:123], v[40:43]
    s_mov_b32 s9, 589824
    s_cbranch_vccnz L_ys_112
    buffer_store_dwordx2 v[50:51], v5, s[72:75], s9 offen
L_yd_113:
    v_mfma_f32_16x16x32_bf16 v[44:47], v[56:59], v[108:111], 0
    ds_read_b128 v[88:91], v2 offset:2112
    v_mfma_f32_16x16x32_bf16 v[44:47], v[80:83], v[112:115], v[44:47]
    s_mov_b32 s9, 1179648
    s_cbranch_vccnz L_ys_114
    buffer_store_dwordx2 v[52:53], v5, s[72:75], s9 offen
L_yd_115:
    ds_read_b128 v[96:99], v1 offset:2176
    v_mfma_f32_16x16x32_bf16 v[44:47], v[116:119], v[120:123], v[44:47]
    ds_read_b128 v[100:103], v2 offset:3712
    v_mfma_f32_16x16x32_bf16 v[44:47], v[104:107], v[60:63], v[44:47]
    s_mov_b32 s9, 1769472
    s_cbranch_vccnz L_ys_116
    buffer_store_dwordx2 v[54:55], v5, s[72:75], s9 offen
L_yd_117:
    ds_read_b128 v[108:111], v1 offset:2688
    s_waitcnt lgkmcnt(6)
    v_mfma_f32_16x16x32_bf16 v[32:35], v[64:67], v[68:71], v[32:35]
    ds_read_b128 v[56:59], v2 offset:3200
    v_mfma_f32_16x16x32_bf16 v[36:39], v[72:75], v[68:71], v[36:39]
    ds_read_b128 v[80:83], v1 offset:3200
    v_mfma_f32_16x16x32_bf16 v[36:39], v[64:67], v[76:79], v[36:39]
    ds_read_b128 v[112:115], v2 offset:2688
    v_mfma_f32_16x16x32_bf16 v[40:43], v[124:127], v[68:71], v[40:43]
    ds_read_b128 v[116:119], v1 offset:3712
    v_mfma_f32_16x16x32_bf16 v[40:43], v[72:75], v[76:79], v[40:43]
    s_waitcnt lgkmcnt(7)
    v_mfma_f32_16x16x32_bf16 v[40:43], v[64:67], v[84:87], v[40:43]
    v_mfma_f32_16x16x32_bf16 v[44:47], v[92:95], v[68:71], v[44:47]
    ds_read_b128 v[120:123], v2 offset:2176
    v_mfma_f32_16x16x32_bf16 v[44:47], v[124:127], v[76:79], v[44:47]
    ds_read_b128 v[104:107], v1 offset:2240
    v_mfma_f32_16x16x32_bf16 v[44:47], v[72:75], v[84:87], v[44:47]
    ds_read_b128 v[60:63], v2 offset:3776
    v_mfma_f32_16x16x32_bf16 v[44:47], v[64:67], v[88:91], v[44:47]
    ds_read_b128 v[92:95], v1 offset:2752
    s_waitcnt lgkmcnt(6)
    v_mfma_f32_16x16x32_bf16 v[32:35], v[96:99], v[100:103], v[32:35]
    ds_read_b128 v[68:71], v2 offset:3264
    v_mfma_f32_16x16x32_bf16 v[36:39], v[108:111], v[100:103], v[36:39]
    ds_read_b128 v[76:79], v1 offset:3264
    v_mfma_f32_16x16x32_bf16 v[36:39], v[96:99], v[56:59], v[36:39]
    ds_read_b128 v[124:127], v2 offset:2752
    v_mfma_f32_16x16x32_bf16 v[40:43], v[80:83], v[100:103], v[40:43]
    ds_read_b128 v[72:75], v1 offset:3776
    v_mfma_f32_16x16x32_bf16 v[40:43], v[108:111], v[56:59], v[40:43]
    s_waitcnt lgkmcnt(7)
    v_mfma_f32_16x16x32_bf16 v[40:43], v[96:99], v[112:115], v[40:43]
    v_mfma_f32_16x16x32_bf16 v[44:47], v[116:119], v[100:103], v[44:47]
    ds_read_b128 v[84:87], v2 offset:2240
    v_mfma_f32_16x16x32_bf16 v[44:47], v[80:83], v[56:59], v[44:47]
    ds_read_b128 v[88:91], v1 offset:2304
    v_mfma_f32_16x16x32_bf16 v[44:47], v[108:111], v[112:115], v[44:47]
    ds_read_b128 v[64:67], v2 offset:3840
    v_mfma_f32_16x16x32_bf16 v[44:47], v[96:99], v[120:123], v[44:47]
    ds_read_b128 v[100:103], v1 offset:2816
    s_waitcnt lgkmcnt(6)
    v_mfma_f32_16x16x32_bf16 v[32:35], v[104:107], v[60:63], v[32:35]
    ds_read_b128 v[116:119], v2 offset:3328
    v_mfma_f32_16x16x32_bf16 v[36:39], v[92:95], v[60:63], v[36:39]
    ds_read_b128 v[80:83], v1 offset:3328
    v_mfma_f32_16x16x32_bf16 v[36:39], v[104:107], v[68:71], v[36:39]
    ds_read_b128 v[56:59], v2 offset:2816
    v_mfma_f32_16x16x32_bf16 v[40:43], v[76:79], v[60:63], v[40:43]
    ds_read_b128 v[108:111], v1 offset:3840
    v_mfma_f32_16x16x32_bf16 v[40:43], v[92:95], v[68:71], v[40:43]
    s_waitcnt lgkmcnt(7)
    v_mfma_f32_16x16x32_bf16 v[40:43], v[104:107], v[124:127], v[40:43]
    v_mfma_f32_16x16x32_bf16 v[44:47], v[72:75], v[60:63], v[44:47]
    ds_read_b128 v[112:115], v2 offset:2304
    v_mfma_f32_16x16x32_bf16 v[44:47], v[76:79], v[68:71], v[44:47]
    ds_read_b128 v[96:99], v1 offset:2368
    v_mfma_f32_16x16x32_bf16 v[44:47], v[92:95], v[124:127], v[44:47]
    ds_read_b128 v[120:123], v2 offset:3904
    v_mfma_f32_16x16x32_bf16 v[44:47], v[104:107], v[84:87], v[44:47]
    ds_read_b128 v[72:75], v1 offset:2880
    s_waitcnt lgkmcnt(6)
    v_mfma_f32_16x16x32_bf16 v[32:35], v[88:91], v[64:67], v[32:35]
    ds_read_b128 v[60:63], v2 offset:3392
    v_mfma_f32_16x16x32_bf16 v[36:39], v[100:103], v[64:67], v[36:39]
    s_sub_u32 s21, s13, 2048
    s_waitcnt vmcnt(0)
    s_mov_b64 exec, 15
    s_cmp_eq_u32 s12, 0
    s_cbranch_scc0 L_ma_118
    buffer_store_dword v14, v11, s[80:83], s21 offen
L_mb_119:
    s_mov_b64 exec, -1
    ds_read_b128 v[76:79], v1 offset:3392
    v_mfma_f32_16x16x32_bf16 v[36:39], v[88:91], v[116:119], v[36:39]
    ds_read_b128 v[68:71], v2 offset:2880
    v_mfma_f32_16x16x32_bf16 v[40:43], v[80:83], v[64:67], v[40:43]
    ds_read_b128 v[92:95], v1 offset:3904
    v_mfma_f32_16x16x32_bf16 v[40:43], v[100:103], v[116:119], v[40:43]
    s_waitcnt lgkmcnt(7)
    v_mfma_f32_16x16x32_bf16 v[40:43], v[88:91], v[56:59], v[40:43]
    v_mfma_f32_16x16x32_bf16 v[44:47], v[108:111], v[64:67], v[44:47]
    ds_read_b128 v[124:127], v2 offset:2368
    v_mfma_f32_16x16x32_bf16 v[44:47], v[80:83], v[116:119], v[44:47]
    ds_read_b128 v[84:87], v1 offset:2432
    v_mfma_f32_16x16x32_bf16 v[44:47], v[100:103], v[56:59], v[44:47]
    ds_read_b128 v[104:107], v2 offset:3968
    v_mfma_f32_16x16x32_bf16 v[44:47], v[88:91], v[112:115], v[44:47]
    ds_read_b128 v[108:111], v1 offset:2944
    s_waitcnt lgkmcnt(6)
    v_mfma_f32_16x16x32_bf16 v[32:35], v[96:99], v[120:123], v[32:35]
    ds_read_b128 v[64:67], v2 offset:3456
    v_mfma_f32_16x16x32_bf16 v[36:39], v[72:75], v[120:123], v[36:39]
    ds_read_b128 v[80:83], v1 offset:3456
    v_mfma_f32_16x16x32_bf16 v[36:39], v[96:99], v[60:63], v[36:39]
    ds_read_b128 v[116:119], v2 offset:2944
    v_mfma_f32_16x16x32_bf16 v[40:43], v[76:79], v[120:123], v[40:43]
    ds_read_b128 v[100:103], v1 offset:3968
    v_mfma_f32_16x16x32_bf16 v[40:43], v[72:75], v[60:63], v[40:43]
    s_waitcnt lgkmcnt(7)
    v_mfma_f32_16x16x32_bf16 v[40:43], v[96:99], v[68:71], v[40:43]
    v_mfma_f32_16x16x32_bf16 v[44:47], v[92:95], v[120:123], v[44:47]
    ds_read_b128 v[56:59], v2 offset:2432
    v_mfma_f32_16x16x32_bf16 v[44:47], v[76:79], v[60:63], v[44:47]
    ds_read_b128 v[88:91], v1 offset:2496
    v_mfma_f32_16x16x32_bf16 v[44:47], v[72:75], v[68:71], v[44:47]
    ds_read_b128 v[112:115], v2 offset:4032
    v_mfma_f32_16x16x32_bf16 v[44:47], v[96:99], v[124:127], v[44:47]
    ds_read_b128 v[92:95], v1 offset:3008
    s_waitcnt lgkmcnt(6)
    v_mfma_f32_16x16x32_bf16 v[32:35], v[84:87], v[104:107], v[32:35]
    ds_read_b128 v[120:123], v2 offset:3520
    v_mfma_f32_16x16x32_bf16 v[36:39], v[108:111], v[104:107], v[36:39]
    ds_read_b128 v[76:79], v1 offset:3520
    v_mfma_f32_16x16x32_bf16 v[36:39], v[84:87], v[64:67], v[36:39]
    ds_read_b128 v[60:63], v2 offset:3008
    v_mfma_f32_16x16x32_bf16 v[40:43], v[80:83], v[104:107], v[40:43]
    ds_read_b128 v[72:75], v1 offset:4032
    v_mfma_f32_16x16x32_bf16 v[40:43], v[108:111], v[64:67], v[40:43]
    s_waitcnt lgkmcnt(7)
    v_mfma_f32_16x16x32_bf16 v[40:43], v[84:87], v[116:119], v[40:43]
    v_mfma_f32_16x16x32_bf16 v[44:47], v[100:103], v[104:107], v[44:47]
    ds_read_b128 v[68:71], v2 offset:2496
    v_mfma_f32_16x16x32_bf16 v[44:47], v[80:83], v[64:67], v[44:47]
    ds_read_b32 v12, v9 offset:36
    v_mfma_f32_16x16x32_bf16 v[44:47], v[108:111], v[116:119], v[44:47]
    ds_read_b128 v[96:99], v1 offset:0
    v_mfma_f32_16x16x32_bf16 v[44:47], v[84:87], v[56:59], v[44:47]
    s_waitcnt lgkmcnt(5)
    v_mfma_f32_16x16x32_bf16 v[32:35], v[88:91], v[112:115], v[32:35]
    v_mfma_f32_16x16x32_bf16 v[36:39], v[92:95], v[112:115], v[36:39]
    v_mfma_f32_16x16x32_bf16 v[36:39], v[88:91], v[120:123], v[36:39]
    s_waitcnt lgkmcnt(1)
    v_readfirstlane_b32 s8, v12
    s_cmp_ge_u32 s8, 4
    s_cbranch_scc0 L_ckc_121
L_ck_120:
    ds_read_b128 v[124:127], v2 offset:1536
    v_mfma_f32_16x16x32_bf16 v[40:43], v[76:79], v[112:115], v[40:43]
    ds_read_b128 v[100:103], v2 offset:1024
    v_mfma_f32_16x16x32_bf16 v[40:43], v[92:95], v[120:123], v[40:43]
    ds_read_b128 v[104:107], v1 offset:512
    v_mfma_f32_16x16x32_bf16 v[40:43], v[88:91], v[60:63], v[40:43]
    ds_read_b128 v[80:83], v2 offset:512
    v_mfma_f32_16x16x32_bf16 v[44:47], v[72:75], v[112:115], v[44:47]
    ds_read_b128 v[64:67], v1 offset:1024
    v_mfma_f32_16x16x32_bf16 v[44:47], v[76:79], v[120:123], v[44:47]
    ds_read_b128 v[108:111], v2 offset:0
    v_mfma_f32_16x16x32_bf16 v[44:47], v[92:95], v[60:63], v[44:47]
    ds_read_b128 v[116:119], v1 offset:1536
    v_mfma_f32_16x16x32_bf16 v[44:47], v[88:91], v[68:71], v[44:47]
    ds_read_b128 v[84:87], v1 offset:64
    s_waitcnt lgkmcnt(7)
    v_mfma_f32_16x16x32_bf16 v[32:35], v[96:99], v[124:127], v[32:35]
    ds_read_b128 v[56:59], v2 offset:1600
    s_waitcnt lgkmcnt(7)
    v_mfma_f32_16x16x32_bf16 v[36:39], v[96:99], v[100:103], v[36:39]
    ds_read_b128 v[72:75], v2 offset:1088
    s_waitcnt lgkmcnt(7)
    v_mfma_f32_16x16x32_bf16 v[36:39], v[104:107], v[124:127], v[36:39]
    ds_read_b128 v[112:115], v1 offset:576
    s_waitcnt lgkmcnt(7)
    v_mfma_f32_16x16x32_bf16 v[40:43], v[96:99], v[80:83], v[40:43]
    ds_read_b128 v[76:79], v2 offset:576
    v_mfma_f32_16x16x32_bf16 v[40:43], v[104:107], v[100:103], v[40:43]
    ds_read_b128 v[120:123], v1 offset:1088
    s_waitcnt lgkmcnt(8)
    v_mfma_f32_16x16x32_bf16 v[40:43], v[64:67], v[124:127], v[40:43]
    ds_read_b128 v[92:95], v2 offset:64
    s_waitcnt lgkmcnt(8)
    v_mfma_f32_16x16x32_bf16 v[44:47], v[96:99], v[108:111], v[44:47]
    ds_read_b128 v[60:63], v1 offset:1600
    v_mfma_f32_16x16x32_bf16 v[44:47], v[104:107], v[80:83], v[44:47]
    ds_read_b128 v[88:91], v1 offset:128
    v_mfma_f32_16x16x32_bf16 v[44:47], v[64:67], v[100:103], v[44:47]
    ds_read_b128 v[68:71], v2 offset:1664
    s_waitcnt lgkmcnt(8)
    v_mfma_f32_16x16x32_bf16 v[44:47], v[116:119], v[124:127], v[44:47]
    ds_read_b128 v[96:99], v2 offset:1152
    v_mfma_f32_16x16x32_bf16 v[32:35], v[84:87], v[56:59], v[32:35]
    ds_read_b128 v[108:111], v1 offset:640
    s_waitcnt lgkmcnt(8)
    v_mfma_f32_16x16x32_bf16 v[36:39], v[84:87], v[72:75], v[36:39]
    ds_read_b128 v[80:83], v2 offset:640
    v_mfma_f32_16x16x32_bf16 v[36:39], v[112:115], v[56:59], v[36:39]
    ds_read_b128 v[104:107], v1 offset:1152
    s_waitcnt lgkmcnt(8)
    v_mfma_f32_16x16x32_bf16 v[40:43], v[84:87], v[76:79], v[40:43]
    ds_read_b128 v[100:103], v2 offset:128
    v_mfma_f32_16x16x32_bf16 v[40:43], v[112:115], v[72:75], v[40:43]
    v_mfma_f32_16x16x32_bf16 v[40:43], v[120:123], v[56:59], v[40:43]
    s_waitcnt lgkmcnt(6)
    v_mfma_f32_16x16x32_bf16 v[44:47], v[84:87], v[92:95], v[44:47]
    ds_read_b128 v[64:67], v1 offset:1664
    v_mfma_f32_16x16x32_bf16 v[44:47], v[112:115], v[76:79], v[44:47]
    ds_read_b128 v[116:119], v1 offset:192
    v_mfma_f32_16x16x32_bf16 v[44:47], v[120:123], v[72:75], v[44:47]
    ds_read_b128 v[124:127], v2 offset:1728
    v_mfma_f32_16x16x32_bf16 v[44:47], v[60:63], v[56:59], v[44:47]
    ds_read_b128 v[84:87], v2 offset:1216
    s_waitcnt lgkmcnt(6)
    v_mfma_f32_16x16x32_bf16 v[32:35], v[88:91], v[68:71], v[32:35]
    ds_read_b128 v[92:95], v1 offset:704
    v_mfma_f32_16x16x32_bf16 v[36:39], v[88:91], v[96:99], v[36:39]
    ds_read_b128 v[76:79], v2 offset:704
    v_mfma_f32_16x16x32_bf16 v[36:39], v[108:111], v[68:71], v[36:39]
    ds_read_b128 v[112:115], v1 offset:1216
    v_mfma_f32_16x16x32_bf16 v[40:43], v[88:91], v[80:83], v[40:43]
    ds_read_b128 v[72:75], v2 offset:192
    v_mfma_f32_16x16x32_bf16 v[40:43], v[108:111], v[96:99], v[40:43]
    s_waitcnt lgkmcnt(7)
    v_mfma_f32_16x16x32_bf16 v[40:43], v[104:107], v[68:71], v[40:43]
    v_mfma_f32_16x16x32_bf16 v[44:47], v[88:91], v[100:103], v[44:47]
    ds_read_b128 v[120:123], v1 offset:1728
    v_mfma_f32_16x16x32_bf16 v[44:47], v[108:111], v[80:83], v[44:47]
    ds_read_b128 v[56:59], v1 offset:256
    v_mfma_f32_16x16x32_bf16 v[44:47], v[104:107], v[96:99], v[44:47]
    ds_read_b128 v[60:63], v2 offset:1792
    v_mfma_f32_16x16x32_bf16 v[44:47], v[64:67], v[68:71], v[44:47]
    ds_read_b128 v[88:91], v2 offset:1280
    s_waitcnt lgkmcnt(6)
    v_mfma_f32_16x16x32_bf16 v[32:35], v[116:119], v[124:127], v[32:35]
    ds_read_b128 v[100:103], v1 offset:768
    v_mfma_f32_16x16x32_bf16 v[36:39], v[116:119], v[84:87], v[36:39]
    ds_read_b128 v[80:83], v2 offset:768
    v_mfma_f32_16x16x32_bf16 v[36:39], v[92:95], v[124:127], v[36:39]
    ds_read_b128 v[108:111], v1 offset:1280
    v_mfma_f32_16x16x32_bf16 v[40:43], v[116:119], v[76:79], v[40:43]
    ds_read_b128 v[96:99], v2 offset:256
    v_mfma_f32_16x16x32_bf16 v[40:43], v[92:95], v[84:87], v[40:43]
    s_waitcnt lgkmcnt(7)
    v_mfma_f32_16x16x32_bf16 v[40:43], v[112:115], v[124:127], v[40:43]
    v_mfma_f32_16x16x32_bf16 v[44:47], v[116:119], v[72:75], v[44:47]
    ds_read_b128 v[104:107], v1 offset:1792
    v_mfma_f32_16x16x32_bf16 v[44:47], v[92:95], v[76:79], v[44:47]
    ds_read_b128 v[64:67], v1 offset:320
    v_mfma_f32_16x16x32_bf16 v[44:47], v[112:115], v[84:87], v[44:47]
    ds_read_b128 v[68:71], v2 offset:1856
    v_mfma_f32_16x16x32_bf16 v[44:47], v[120:123], v[124:127], v[44:47]
    ds_read_b128 v[72:75], v2 offset:1344
    s_waitcnt lgkmcnt(6)
    v_mfma_f32_16x16x32_bf16 v[32:35], v[56:59], v[60:63], v[32:35]
    ds_read_b128 v[116:119], v1 offset:832
    v_mfma_f32_16x16x32_bf16 v[36:39], v[56:59], v[88:91], v[36:39]
    ds_read_b128 v[76:79], v2 offset:832
    v_mfma_f32_16x16x32_bf16 v[36:39], v[100:103], v[60:63], v[36:39]
    ds_read_b128 v[92:95], v1 offset:1344
    v_mfma_f32_16x16x32_bf16 v[40:43], v[56:59], v[80:83], v[40:43]
    ds_read_b128 v[84:87], v2 offset:320
    v_mfma_f32_16x16x32_bf16 v[40:43], v[100:103], v[88:91], v[40:43]
    s_waitcnt lgkmcnt(7)
    v_mfma_f32_16x16x32_bf16 v[40:43], v[108:111], v[60:63], v[40:43]
    v_mfma_f32_16x16x32_bf16 v[44:47], v[56:59], v[96:99], v[44:47]
    ds_read_b128 v[112:115], v1 offset:1856
    v_mfma_f32_16x16x32_bf16 v[44:47], v[100:103], v[80:83], v[44:47]
    ds_read_b128 v[120:123], v1 offset:384
    v_mfma_f32_16x16x32_bf16 v[44:47], v[108:111], v[88:91], v[44:47]
    ds_read_b128 v[124:127], v2 offset:1920
    v_mfma_f32_16x16x32_bf16 v[44:47], v[104:107], v[60:63], v[44:47]
    ds_read_b128 v[96:99], v1 offset:448
    s_waitcnt lgkmcnt(6)
    v_mfma_f32_16x16x32_bf16 v[32:35], v[64:67], v[68:71], v[32:35]
    ds_read_b128 v[56:59], v2 offset:1984
    v_mfma_f32_16x16x32_bf16 v[36:39], v[64:67], v[72:75], v[36:39]
    ds_read_b128 v[80:83], v2 offset:1408
    v_mfma_f32_16x16x32_bf16 v[36:39], v[116:119], v[68:71], v[36:39]
    ds_read_b128 v[100:103], v1 offset:896
    v_mfma_f32_16x16x32_bf16 v[40:43], v[64:67], v[76:79], v[40:43]
    ds_read_b128 v[88:91], v2 offset:1472
    v_mfma_f32_16x16x32_bf16 v[40:43], v[116:119], v[72:75], v[40:43]
    ds_read_b128 v[108:111], v1 offset:960
    s_waitcnt lgkmcnt(8)
    v_mfma_f32_16x16x32_bf16 v[40:43], v[92:95], v[68:71], v[40:43]
    ds_read_b128 v[104:107], v2 offset:896
    v_mfma_f32_16x16x32_bf16 v[44:47], v[64:67], v[84:87], v[44:47]
    ds_read_b128 v[60:63], v1 offset:1408
    v_mfma_f32_16x16x32_bf16 v[44:47], v[116:119], v[76:79], v[44:47]
    ds_read_b128 v[84:87], v2 offset:960
    v_mfma_f32_16x16x32_bf16 v[44:47], v[92:95], v[72:75], v[44:47]
    ds_read_b128 v[64:67], v1 offset:1472
    v_mfma_f32_16x16x32_bf16 v[44:47], v[112:115], v[68:71], v[44:47]
    ds_read_b128 v[76:79], v2 offset:384
    s_waitcnt lgkmcnt(8)
    v_mfma_f32_16x16x32_bf16 v[32:35], v[120:123], v[124:127], v[32:35]
    v_mfma_f32_16x16x32_bf16 v[32:35], v[96:99], v[56:59], v[32:35]
    v_mfma_f32_16x16x32_bf16 v[36:39], v[120:123], v[80:83], v[36:39]
    ds_read_b128 v[116:119], v1 offset:1920
    s_waitcnt lgkmcnt(6)
    v_mfma_f32_16x16x32_bf16 v[36:39], v[100:103], v[124:127], v[36:39]
    ds_read_b128 v[72:75], v2 offset:448
    v_mfma_f32_16x16x32_bf16 v[36:39], v[96:99], v[88:91], v[36:39]
    v_mfma_f32_16x16x32_bf16 v[36:39], v[108:111], v[56:59], v[36:39]
    s_waitcnt lgkmcnt(4)
    v_mfma_f32_16x16x32_bf16 v[40:43], v[120:123], v[104:107], v[40:43]
    ds_read_b128 v[92:95], v1 offset:1984
    v_mfma_f32_16x16x32_bf16 v[40:43], v[100:103], v[80:83], v[40:43]
    v_mfma_f32_16x16x32_bf16 v[40:43], v[60:63], v[124:127], v[40:43]
    v_mfma_f32_16x16x32_bf16 v[40:43], v[96:99], v[84:87], v[40:43]
    v_cvt_pk_bf16_f32 v24, v32, v33
    v_mfma_f32_16x16x32_bf16 v[40:43], v[108:111], v[88:91], v[40:43]
    v_cvt_pk_bf16_f32 v25, v34, v35
    s_waitcnt lgkmcnt(2)
    v_mfma_f32_16x16x32_bf16 v[40:43], v[64:67], v[56:59], v[40:43]
    s_mov_b32 s9, 2359296
    s_cbranch_vccnz L_ys_122
    buffer_store_dwordx2 v[24:25], v5, s[72:75], s9 offen
L_yd_123:
    v_mfma_f32_16x16x32_bf16 v[44:47], v[120:123], v[76:79], v[44:47]
    v_mfma_f32_16x16x32_bf16 v[44:47], v[100:103], v[104:107], v[44:47]
    v_cvt_pk_bf16_f32 v26, v36, v37
    v_mfma_f32_16x16x32_bf16 v[44:47], v[60:63], v[80:83], v[44:47]
    v_cvt_pk_bf16_f32 v27, v38, v39
    v_mfma_f32_16x16x32_bf16 v[44:47], v[116:119], v[124:127], v[44:47]
    s_mov_b32 s9, 2949120
    s_cbranch_vccnz L_ys_124
    buffer_store_dwordx2 v[26:27], v5, s[72:75], s9 offen
L_yd_125:
    s_waitcnt lgkmcnt(0)
    v_mfma_f32_16x16x32_bf16 v[44:47], v[96:99], v[72:75], v[44:47]
    v_mfma_f32_16x16x32_bf16 v[44:47], v[108:111], v[84:87], v[44:47]
    v_mfma_f32_16x16x32_bf16 v[44:47], v[64:67], v[88:91], v[44:47]
    v_mfma_f32_16x16x32_bf16 v[44:47], v[92:95], v[56:59], v[44:47]
    v_cvt_pk_bf16_f32 v28, v40, v41
    v_cvt_pk_bf16_f32 v29, v42, v43
    s_mov_b32 s9, 3538944
    s_cbranch_vccnz L_ys_126
    buffer_store_dwordx2 v[28:29], v5, s[72:75], s9 offen
L_yd_127:
    s_nop 2
    v_cvt_pk_bf16_f32 v30, v44, v45
    v_cvt_pk_bf16_f32 v31, v46, v47
    s_mov_b32 s9, 4128768
    s_cbranch_vccnz L_ys_128
    buffer_store_dwordx2 v[30:31], v5, s[72:75], s9 offen
L_yd_129:
    s_waitcnt vmcnt(0)
    s_mov_b64 exec, 1
    ds_add_u32 v9, v10 offset:52
    s_mov_b64 exec, -1
    s_mov_b64 exec, 15
    s_cmp_eq_u32 s12, 0
    s_cbranch_scc0 L_ma_130
    buffer_store_dword v14, v11, s[80:83], s13 offen
L_mb_131:
    s_mov_b64 exec, -1
    s_endpgm
L_ckc_107:
    s_mov_b32 s14, 0
L_pl_132:
    ds_read_b32 v12, v9 offset:32
    s_add_u32 s14, s14, 1
    s_waitcnt lgkmcnt(0)
    v_readfirstlane_b32 s8, v12
    s_cmp_ge_u32 s8, 1
    s_cbranch_scc1 L_pld_133
    s_sleep 1
    s_cmp_lt_u32 s14, 131072
    s_cbranch_scc1 L_pl_132
L_pld_133:
    s_branch L_ck_106
L_ckc_109:
    s_mov_b32 s14, 0
L_pl_134:
    ds_read_b32 v12, v9 offset:16
    s_add_u32 s14, s14, 1
    s_waitcnt lgkmcnt(0)
    v_readfirstlane_b32 s8, v12
    s_cmp_ge_u32 s8, 4
    s_cbranch_scc1 L_pld_135
    s_sleep 1
    s_cmp_lt_u32 s14, 131072
    s_cbranch_scc1 L_pl_134
L_pld_135:
    s_branch L_ck_108
L_ys_110:
    buffer_store_dwordx2 v[48:49], v5, s[72:75], s9 offen sc1
    s_branch L_yd_111
L_ys_112:
    buffer_store_dwordx2 v[50:51], v5, s[72:75], s9 offen sc1
    s_branch L_yd_113
L_ys_114:
    buffer_store_dwordx2 v[52:53], v5, s[72:75], s9 offen sc1
    s_branch L_yd_115
L_ys_116:
    buffer_store_dwordx2 v[54:55], v5, s[72:75], s9 offen sc1
    s_branch L_yd_117
L_ma_118:
    s_mov_b64 exec, 1
    v_mov_b32 v16, 1
    buffer_atomic_add v16, off, s[60:63], s34 offset:8 sc0 sc1
    s_waitcnt vmcnt(0)
    v_readfirstlane_b32 s8, v16
    s_cmp_eq_u32 s8, 127
    s_cbranch_scc0 L_mb_119
    s_mov_b64 exec, -1
    s_add_u32 s9, s33, 4096
    v_lshlrev_b32 v20, 4, v0
    v_mov_b32 v16, v14
    v_mov_b32 v17, v14
    v_mov_b32 v18, v14
    v_mov_b32 v19, v14
    buffer_store_dwordx4 v[16:19], v20, s[80:83], s9 offen offset:0 sc1
    buffer_store_dwordx4 v[16:19], v20, s[80:83], s9 offen offset:1024 sc1
    buffer_store_dwordx4 v[16:19], v20, s[80:83], s9 offen offset:0
    buffer_store_dwordx4 v[16:19], v20, s[80:83], s9 offen offset:1024
    s_branch L_mb_119
L_ckc_121:
    s_mov_b32 s14, 0
L_pl_136:
    ds_read_b32 v12, v9 offset:36
    s_add_u32 s14, s14, 1
    s_waitcnt lgkmcnt(0)
    v_readfirstlane_b32 s8, v12
    s_cmp_ge_u32 s8, 4
    s_cbranch_scc1 L_pld_137
    s_sleep 1
    s_cmp_lt_u32 s14, 131072
    s_cbranch_scc1 L_pl_136
L_pld_137:
    s_branch L_ck_120
L_ys_122:
    buffer_store_dwordx2 v[24:25], v5, s[72:75], s9 offen sc1
    s_branch L_yd_123
L_ys_124:
    buffer_store_dwordx2 v[26:27], v5, s[72:75], s9 offen sc1
    s_branch L_yd_125
L_ys_126:
    buffer_store_dwordx2 v[28:29], v5, s[72:75], s9 offen sc1
    s_branch L_yd_127
L_ys_128:
    buffer_store_dwordx2 v[30:31], v5, s[72:75], s9 offen sc1
    s_branch L_yd_129
L_ma_130:
    s_mov_b64 exec, 1
    v_mov_b32 v16, 1
    buffer_atomic_add v16, off, s[60:63], s34 offset:12 sc0 sc1
    s_waitcnt vmcnt(0)
    v_readfirstlane_b32 s8, v16
    s_cmp_eq_u32 s8, 127
    s_cbranch_scc0 L_mb_131
    s_mov_b64 exec, -1
    s_add_u32 s9, s33, 6144
    v_lshlrev_b32 v20, 4, v0
    v_mov_b32 v16, v14
    v_mov_b32 v17, v14
    v_mov_b32 v18, v14
    v_mov_b32 v19, v14
    buffer_store_dwordx4 v[16:19], v20, s[80:83], s9 offen offset:0 sc1
    buffer_store_dwordx4 v[16:19], v20, s[80:83], s9 offen offset:1024 sc1
    buffer_store_dwordx4 v[16:19], v20, s[80:83], s9 offen offset:0
    buffer_store_dwordx4 v[16:19], v20, s[80:83], s9 offen offset:1024
    s_branch L_mb_131
L_exit:
    s_endpgm
.section .rodata,"a"
.p2align 6
.amdhsa_kernel concat_heads__ssm_conv_h3__ssm_conv_h3__prompt_kernel
  .amdhsa_next_free_vgpr 128
  .amdhsa_next_free_sgpr 102
  .amdhsa_accum_offset 128
  .amdhsa_group_segment_fixed_size 0
  .amdhsa_kernarg_size 120
  .amdhsa_user_sgpr_count 2
  .amdhsa_user_sgpr_kernarg_segment_ptr 1
  .amdhsa_system_sgpr_workgroup_id_x 1
  .amdhsa_float_denorm_mode_32 3
.end_amdhsa_kernel
```
